```python
import torch

def _softmax(x, axis=-1):
    return torch.softmax(x, dim=axis)
def _gelu(x):
    return torch.nn.functional.gelu(x, approximate="tanh")
def _silu(x):
    return torch.nn.functional.silu(x)
def _sigmoid(x):
    return torch.sigmoid(x)
def _layernorm(x, axis=-1, eps=1e-5):
    m = x.mean(dim=axis, keepdim=True)
    v = x.var(dim=axis, keepdim=True, unbiased=False)
    return (x - m) / torch.sqrt(v + eps)
def _scatter_add(tgt, idx, src, axis=0):
    return tgt.clone().index_add_(axis, idx, src)
def _segment_sum(src, seg, n):
    out = torch.zeros((n,) + src.shape[1:], dtype=src.dtype)
    return out.index_add_(0, seg, src)
def _pad(x, pw):
    flat = tuple(v for pair in reversed(pw) for v in pair)
    return torch.nn.functional.pad(x, flat)

kernel_name = 'recurrent_scan__gqa_block_cached__swiglu_ffn__decode'

def setup_inputs():

    _w = (lambda a: (lambda t: t.to(torch.bfloat16) if t.is_floating_point() else t)(torch.as_tensor(a)))
    def _A_setup():
        B, Sq, D = 1, 1, 1024
        Hq, Hkv, Sk, Dh = 32, 4, 65536, 128
        assert Hq % Hkv == 0, (Hq, Hkv)
        return {
            "x": _w((lambda *s: torch.randn(*s, dtype=torch.bfloat16) * 0.05)(B, Sq, D)),
            "k_cache": _w((lambda *s: torch.randn(*s, dtype=torch.bfloat16) * 1.6)(B, Hkv, Sk, Dh)),
            "v_cache": _w((lambda *s: torch.randn(*s, dtype=torch.bfloat16) * 0.2)(B, Hkv, Sk, Dh)),
            "wq": _w((lambda *s: torch.randn(*s, dtype=torch.bfloat16) * 1.6)(D, Hq * Dh) * (D ** -0.5)),
            "wo": _w((lambda *s: torch.randn(*s, dtype=torch.bfloat16) * 0.2)(Hq * Dh, D) * ((Hq * Dh) ** -0.5)),
        }
    _A_in = _A_setup()

    def _B_setup():
        B, S, D, F = 1, 1, 1024, 3584
        return {
            "x": _w((lambda *s: torch.randn(*s, dtype=torch.bfloat16) * 0.05)(B, S, D)),
            "w_gate": _w((lambda *s: torch.randn(*s, dtype=torch.bfloat16) * 0.1)(D, F)),
            "w_up": _w((lambda *s: torch.randn(*s, dtype=torch.bfloat16) * 0.1)(D, F)),
            "w_down": _w((lambda *s: torch.randn(*s, dtype=torch.bfloat16) * 0.1)(F, D)),
        }
    _B_in = _B_setup()

    return {
        "A_x": _A_in["x"],
        "A_k_cache": _A_in["k_cache"],
        "A_v_cache": _A_in["v_cache"],
        "A_wq": _A_in["wq"],
        "A_wo": _A_in["wo"],
        "B_x": _B_in["x"],
        "B_w_gate": _B_in["w_gate"],
        "B_w_up": _B_in["w_up"],
        "B_w_down": _B_in["w_down"],
    }

def reference(A_x, A_k_cache, A_v_cache, A_wq, A_wo, B_x, B_w_gate, B_w_up, B_w_down):
    def _A_ref(x, k_cache, v_cache, wq, wo):
        B, Sq, D = x.shape
        Hq, Dh = 32, 128
        Hkv = k_cache.shape[1]
        rep = Hq // Hkv
        q = (lambda x, *d: x.permute(*d))((x @ wq).reshape(B, Sq, Hq, Dh), 0, 2, 1, 3)
        k = (lambda x, n, axis: torch.repeat_interleave(x, n, dim=axis))(k_cache, rep, axis=1)
        v = (lambda x, n, axis: torch.repeat_interleave(x, n, dim=axis))(v_cache, rep, axis=1)
        scores = torch.einsum("bhqd,bhkd->bhqk", q, k) * (Dh ** -0.5)
        p = _softmax(scores, axis=-1)
        o = torch.einsum("bhqk,bhkd->bhqd", p, v)
        return (lambda x, *d: x.permute(*d))(o, 0, 2, 1, 3).reshape(B, Sq, Hq * Dh) @ wo

    def _B_ref(x, w_gate, w_up, w_down):
        g = _silu(x @ w_gate)
        u = x @ w_up
        return (g * u) @ w_down

    x = A_x
    xn = _layernorm(x, axis=-1)
    s = _A_ref(xn, A_k_cache, A_v_cache, A_wq, A_wo)
    g = _silu(_B_ref(xn, B_w_gate, B_w_up, B_w_down))
    return x + s * g
```

```asm
; @launch grid=(256,1,1) block=(256,1,1) lds=28672
.amdgcn_target "amdgcn-amd-amdhsa--gfx950"
.text
.globl recurrent_scan__gqa_block_cached__swiglu_ffn__decode_kernel
.p2align 12
.p2align 8
.type recurrent_scan__gqa_block_cached__swiglu_ffn__decode_kernel,@function
recurrent_scan__gqa_block_cached__swiglu_ffn__decode_kernel:
    s_load_dwordx16 s[4:19], s[0:1], 0
    s_load_dwordx8 s[20:27], s[0:1], 64
    s_cmp_ge_u32 s2, 256
    s_cbranch_scc1 L_end
    v_lshrrev_b32 v27, 6, v0
    v_and_b32 v1, 63, v0
    v_readfirstlane_b32 s3, v27
    v_lshlrev_b32 v2, 4, v1
    v_and_b32 v30, 15, v1
    v_lshrrev_b32 v31, 4, v1
    s_and_b32 s98, s2, 3
    s_lshr_b32 s76, s2, 3
    s_bitcmp1_b32 s2, 2
    s_cselect_b32 s77, 28, 28
    s_cselect_b32 s99, 28, 0
    s_cselect_b32 s73, 32, 28
    s_cmp_ge_u32 s76, s77
    s_cselect_b32 s99, s73, s99
    s_add_u32 s99, s99, s76
    v_and_b32 v27, 8, v1
    v_lshlrev_b32 v27, 2, v27
    v_lshl_add_u32 v27, v31, 3, v27
    v_and_b32 v28, 7, v1
    v_lshlrev_b32 v28, 4, v28
    v_lshl_add_u32 v4, v27, 13, v28
    v_mul_u32_u24 v5, 0x1c00, v27
    v_add_u32 v5, v5, v28
    s_lshl_b32 s76, s98, 8
    s_lshl_b32 s77, s3, 6
    s_add_u32 s76, s76, s77
    s_mul_i32 s77, s99, 37
    s_lshr_b32 s77, s77, 8
    s_add_u32 s96, s99, s77
    s_and_b32 s77, s96, 7
    s_cmp_ge_u32 s77, 3
    s_addc_u32 s96, s96, 0
    s_lshl_b32 s77, s99, 3
    s_sub_u32 s77, s77, 445
    s_cmp_ge_u32 s99, 56
    s_cselect_b32 s96, s77, s96
    s_xor_b32 s97, s99, 4
    s_lshl_b32 s77, s96, 7
    s_lshl_b32 s78, s76, 13
    s_add_u32 s78, s78, s77
    s_mul_i32 s79, s76, 7168
    s_lshl_b32 s77, s97, 7
    s_add_u32 s95, s79, s77
    s_lshl_b32 s77, s99, 7
    s_add_u32 s79, s79, s77
    s_lshl_b32 s76, s76, 1
    v_and_b32 v27, 1, v1
    v_lshlrev_b32 v27, 6, v27
    v_lshl_add_u32 v29, v31, 4, v27
    s_bfe_u32 s74, s2, 0x20003
    s_lshr_b32 s75, s2, 5
    s_lshl_b32 s75, s75, 3
    s_and_b32 s77, s2, 7
    s_or_b32 s75, s75, s77
    s_lshl_b32 s72, s74, 24
    s_bfe_u32 s77, s75, 65536
    s_lshl_b32 s77, s77, 20
    s_or_b32 s72, s72, s77
    s_bfe_u32 s77, s75, 65537
    s_lshl_b32 s77, s77, 18
    s_or_b32 s72, s72, s77
    s_bfe_u32 s77, s75, 65538
    s_lshl_b32 s77, s77, 17
    s_or_b32 s72, s72, s77
    s_bfe_u32 s77, s75, 65539
    s_lshl_b32 s77, s77, 15
    s_or_b32 s72, s72, s77
    s_bfe_u32 s77, s75, 65540
    s_lshl_b32 s77, s77, 14
    s_or_b32 s72, s72, s77
    s_bfe_u32 s77, s75, 65541
    s_lshl_b32 s77, s77, 21
    s_or_b32 s72, s72, s77
    s_bfe_u32 s77, s3, 65536
    s_lshl_b32 s77, s77, 13
    s_or_b32 s72, s72, s77
    s_bfe_u32 s77, s3, 65537
    s_lshl_b32 s77, s77, 12
    s_or_b32 s72, s72, s77
    v_and_b32 v27, 12, v1
    v_lshlrev_b32 v3, 6, v27
    v_lshl_add_u32 v3, v31, 6, v3
    v_and_b32 v27, 3, v1
    v_lshl_add_u32 v3, v27, 4, v3
    s_mov_b32 s38, 8388608
    s_mov_b32 s39, 0x20000
    s_mov_b32 s30, 67108864
    s_mov_b32 s31, 0x20000
    s_mov_b32 s62, 2048
    s_mov_b32 s63, 0x20000
    s_waitcnt lgkmcnt(0)
    s_mov_b32 s36, s10
    s_mov_b32 s37, s11
    s_add_u32 s73, s78, 0
    buffer_load_dwordx4 v[128:131], v4, s[36:39], s73 offen nt
    s_mov_b32 s28, s6
    s_mov_b32 s29, s7
    s_add_u32 s73, s72, 0
    buffer_load_dwordx4 a[0:3], v3, s[28:31], s73 offen nt
    s_add_u32 s73, s78, 8192
    buffer_load_dwordx4 v[132:135], v4, s[36:39], s73 offen nt
    s_add_u32 s73, s72, 0
    buffer_load_dwordx4 a[4:7], v3, s[28:31], s73 offen offset:1024 nt
    s_add_u32 s73, s78, 16384
    buffer_load_dwordx4 v[136:139], v4, s[36:39], s73 offen nt
    s_add_u32 s73, s72, 0
    buffer_load_dwordx4 a[8:11], v3, s[28:31], s73 offen offset:2048 nt
    s_mov_b32 s60, s4
    s_mov_b32 s61, s5
    buffer_load_dwordx4 v[224:227], v2, s[60:63], 0 offen
    buffer_load_dwordx4 v[228:231], v2, s[60:63], 0 offen offset:1024
    buffer_load_dwordx4 v[232:235], v29, s[60:63], s76 offen
    s_add_u32 s73, s78, 24576
    buffer_load_dwordx4 v[140:143], v4, s[36:39], s73 offen nt
    s_add_u32 s73, s72, 0
    buffer_load_dwordx4 a[12:15], v3, s[28:31], s73 offen offset:3072 nt
    s_add_u32 s73, s78, 32768
    buffer_load_dwordx4 v[144:147], v4, s[36:39], s73 offen nt
    s_add_u32 s73, s72, 524288
    buffer_load_dwordx4 a[16:19], v3, s[28:31], s73 offen nt
    s_mov_b32 s44, s16
    s_mov_b32 s45, s17
    s_mov_b32 s46, 7340032
    s_mov_b32 s47, 0x20000
    s_mov_b32 s48, s18
    s_mov_b32 s49, s19
    s_mov_b32 s50, 7340032
    s_mov_b32 s51, 0x20000
    s_mov_b32 s56, s26
    s_mov_b32 s57, s27
    s_mov_b32 s58, 2281472
    s_mov_b32 s59, 0x20000
    s_cmp_ge_u32 s99, 56
    s_cselect_b32 s46, 0, s46
    s_cselect_b32 s50, 0, s50
    s_mov_b32 s32, s8
    s_mov_b32 s33, s9
    s_mov_b32 s34, 67108864
    s_mov_b32 s35, 0x20000
    s_mov_b32 s40, s12
    s_mov_b32 s41, s13
    s_mov_b32 s42, 8388608
    s_mov_b32 s43, 0x20000
    s_mov_b32 s52, s20
    s_mov_b32 s53, s21
    s_mov_b32 s54, 7340032
    s_mov_b32 s55, 0x20000
    s_mov_b32 s64, s22
    s_mov_b32 s65, s23
    s_mov_b32 s66, 2048
    s_mov_b32 s67, 0x20000
    s_mov_b32 s82, 0x05040100
    s_mov_b32 s83, 0x07060302
    s_mov_b32 s84, 0x0c0c0100
    s_mov_b32 s85, 0x0c0c0302
    s_mov_b32 s86, 0xffff0000
    s_mov_b32 s91, 0x3fb8aa3b
    s_add_u32 s73, s78, 40960
    s_waitcnt vmcnt(9)
    buffer_load_dwordx4 v[148:151], v4, s[36:39], s73 offen nt
    s_lshr_b32 s76, s75, 4
    s_lshl_b32 s76, s76, 3
    s_and_b32 s77, s75, 7
    s_or_b32 s76, s76, s77
    s_bfe_u32 s89, s75, 0x10003
    s_lshl_b32 s88, s74, 5
    s_add_u32 s88, s88, s76
    s_lshl_b32 s89, s89, 10
    s_lshl_b32 s77, s3, 8
    s_add_u32 s89, s89, s77
    s_add_u32 s73, s72, 524288
    s_waitcnt vmcnt(9)
    buffer_load_dwordx4 a[20:23], v3, s[28:31], s73 offen offset:1024 nt
    s_lshl_b32 s81, s74, 10
    s_and_b32 s77, s76, 2
    s_lshl_b32 s77, s77, 8
    s_add_u32 s81, s81, s77
    s_and_b32 s77, s76, 1
    s_lshl_b32 s77, s77, 6
    s_add_u32 s81, s81, s77
    s_lshr_b32 s77, s76, 2
    s_add_u32 s81, s81, s77
    s_lshl_b32 s81, s81, 11
    s_add_u32 s81, s81, s89
    v_lshlrev_b32 v27, 4, v30
    v_lshl_add_u32 v7, v31, 15, v27
    v_mul_u32_u24 v6, 14336, v31
    v_add_u32 v6, v6, v27
    s_add_u32 s73, s78, 49152
    s_waitcnt vmcnt(9)
    buffer_load_dwordx4 v[152:155], v4, s[36:39], s73 offen nt
    s_and_b32 s90, s2, 7
    s_mul_i32 s90, s90, 8
    s_and_b32 s77, s2, 63
    s_lshr_b32 s77, s77, 3
    s_add_u32 s90, s90, s77
    v_mov_b32 v28, 492032
    buffer_load_dword v127, v28, s[56:59], 0 offen sc1
    s_mov_b32 s6, 0xffffff00
    s_lshl_b32 s76, s90, 5
    v_and_b32 v27, 15, v1
    v_lshlrev_b32 v27, 1, v27
    buffer_load_ushort v26, v27, s[60:63], s76 offen
    s_waitcnt vmcnt(9)
    v_lshlrev_b32 v32, 16, v224
    v_and_b32 v33, s86, v224
    v_lshlrev_b32 v34, 16, v225
    v_and_b32 v35, s86, v225
    v_lshlrev_b32 v36, 16, v226
    v_and_b32 v37, s86, v226
    v_lshlrev_b32 v38, 16, v227
    v_and_b32 v39, s86, v227
    v_lshlrev_b32 v40, 16, v228
    v_and_b32 v41, s86, v228
    v_lshlrev_b32 v42, 16, v229
    v_and_b32 v43, s86, v229
    v_lshlrev_b32 v44, 16, v230
    v_and_b32 v45, s86, v230
    v_lshlrev_b32 v46, 16, v231
    v_and_b32 v47, s86, v231
    s_add_u32 s73, s72, 524288
    s_waitcnt vmcnt(8)
    buffer_load_dwordx4 a[24:27], v3, s[28:31], s73 offen offset:2048 nt
    v_add_f32 v48, v32, v33
    v_add_f32 v49, v34, v35
    v_add_f32 v48, v48, v36
    v_add_f32 v49, v49, v37
    v_add_f32 v48, v48, v38
    v_add_f32 v49, v49, v39
    v_add_f32 v48, v48, v40
    v_add_f32 v49, v49, v41
    v_add_f32 v48, v48, v42
    v_add_f32 v49, v49, v43
    v_add_f32 v48, v48, v44
    v_add_f32 v49, v49, v45
    v_add_f32 v48, v48, v46
    v_add_f32 v49, v49, v47
    v_add_f32 v48, v48, v49
    s_nop 1
    v_add_f32_dpp v48, v48, v48 row_ror:8 row_mask:0xf bank_mask:0xf
    s_nop 1
    v_add_f32_dpp v48, v48, v48 row_ror:4 row_mask:0xf bank_mask:0xf
    s_nop 1
    v_add_f32_dpp v48, v48, v48 row_ror:2 row_mask:0xf bank_mask:0xf
    s_nop 1
    v_add_f32_dpp v48, v48, v48 row_ror:1 row_mask:0xf bank_mask:0xf
    v_mov_b32 v27, v48
    s_nop 1
    v_permlane16_swap_b32 v48, v27
    v_add_f32 v48, v48, v27
    v_mov_b32 v27, v48
    s_nop 1
    v_permlane32_swap_b32 v48, v27
    v_add_f32 v48, v48, v27
    s_add_u32 s73, s78, 57344
    s_waitcnt vmcnt(8)
    buffer_load_dwordx4 v[156:159], v4, s[36:39], s73 offen nt
    v_mul_f32 v48, 0x3a800000, v48
    v_sub_f32 v32, v32, v48
    v_sub_f32 v33, v33, v48
    v_sub_f32 v34, v34, v48
    v_sub_f32 v35, v35, v48
    v_sub_f32 v36, v36, v48
    v_sub_f32 v37, v37, v48
    v_sub_f32 v38, v38, v48
    v_sub_f32 v39, v39, v48
    v_sub_f32 v40, v40, v48
    v_sub_f32 v41, v41, v48
    v_sub_f32 v42, v42, v48
    v_sub_f32 v43, v43, v48
    v_sub_f32 v44, v44, v48
    v_sub_f32 v45, v45, v48
    v_sub_f32 v46, v46, v48
    v_sub_f32 v47, v47, v48
    v_mul_f32 v49, v32, v32
    v_mul_f32 v50, v33, v33
    v_fmac_f32 v49, v34, v34
    v_fmac_f32 v50, v35, v35
    v_fmac_f32 v49, v36, v36
    v_fmac_f32 v50, v37, v37
    v_fmac_f32 v49, v38, v38
    v_fmac_f32 v50, v39, v39
    v_fmac_f32 v49, v40, v40
    v_fmac_f32 v50, v41, v41
    v_fmac_f32 v49, v42, v42
    v_fmac_f32 v50, v43, v43
    v_fmac_f32 v49, v44, v44
    v_fmac_f32 v50, v45, v45
    v_fmac_f32 v49, v46, v46
    v_fmac_f32 v50, v47, v47
    v_add_f32 v49, v49, v50
    s_add_u32 s73, s72, 524288
    s_waitcnt vmcnt(8)
    buffer_load_dwordx4 a[28:31], v3, s[28:31], s73 offen offset:3072 nt
    v_add_f32_dpp v49, v49, v49 row_ror:8 row_mask:0xf bank_mask:0xf
    s_nop 1
    v_add_f32_dpp v49, v49, v49 row_ror:4 row_mask:0xf bank_mask:0xf
    s_nop 1
    v_add_f32_dpp v49, v49, v49 row_ror:2 row_mask:0xf bank_mask:0xf
    s_nop 1
    v_add_f32_dpp v49, v49, v49 row_ror:1 row_mask:0xf bank_mask:0xf
    v_mov_b32 v27, v49
    s_nop 1
    v_permlane16_swap_b32 v49, v27
    v_add_f32 v49, v49, v27
    v_mov_b32 v27, v49
    s_nop 1
    v_permlane32_swap_b32 v49, v27
    v_add_f32 v49, v49, v27
    s_add_u32 s73, s79, 0
    s_waitcnt vmcnt(8)
    buffer_load_dwordx4 v[160:163], v5, s[44:47], s73 offen nt
    v_mul_f32 v49, 0x3a800000, v49
    v_cvt_pk_bf16_f32 v48, v48, v48
    v_lshlrev_b32 v48, 16, v48
    v_cvt_pk_bf16_f32 v49, v49, v49
    v_lshlrev_b32 v49, 16, v49
    v_add_f32 v49, 0x3727c5ac, v49
    v_cvt_pk_bf16_f32 v49, v49, v49
    v_lshlrev_b32 v49, 16, v49
    v_sqrt_f32 v49, v49
    s_nop 0
    v_cvt_pk_bf16_f32 v49, v49, v49
    v_lshlrev_b32 v49, 16, v49
    v_rcp_f32 v50, v49
    v_lshlrev_b32 v32, 16, v232
    v_and_b32 v33, s86, v232
    v_lshlrev_b32 v34, 16, v233
    v_and_b32 v35, s86, v233
    v_lshlrev_b32 v36, 16, v234
    v_and_b32 v37, s86, v234
    v_lshlrev_b32 v38, 16, v235
    v_and_b32 v39, s86, v235
    s_add_u32 s73, s72, 65536
    s_waitcnt vmcnt(8)
    buffer_load_dwordx4 a[32:35], v3, s[28:31], s73 offen nt
    v_sub_f32 v32, v32, v48
    v_sub_f32 v33, v33, v48
    v_sub_f32 v34, v34, v48
    v_sub_f32 v35, v35, v48
    v_sub_f32 v36, v36, v48
    v_sub_f32 v37, v37, v48
    v_sub_f32 v38, v38, v48
    v_sub_f32 v39, v39, v48
    v_cvt_pk_bf16_f32 v8, v32, v33
    v_cvt_pk_bf16_f32 v9, v34, v35
    v_cvt_pk_bf16_f32 v10, v36, v37
    v_cvt_pk_bf16_f32 v11, v38, v39
    v_lshlrev_b32 v32, 16, v8
    v_and_b32 v33, s86, v8
    v_lshlrev_b32 v34, 16, v9
    v_and_b32 v35, s86, v9
    v_lshlrev_b32 v36, 16, v10
    v_and_b32 v37, s86, v10
    v_lshlrev_b32 v38, 16, v11
    v_and_b32 v39, s86, v11
    s_add_u32 s73, s79, 7168
    s_waitcnt vmcnt(8)
    buffer_load_dwordx4 v[164:167], v5, s[44:47], s73 offen nt
    v_mul_f32 v40, v32, v50
    v_mul_f32 v41, v33, v50
    v_mul_f32 v42, v34, v50
    v_mul_f32 v43, v35, v50
    v_mul_f32 v44, v36, v50
    v_mul_f32 v45, v37, v50
    v_mul_f32 v46, v38, v50
    v_mul_f32 v47, v39, v50
    v_fma_f32 v32, -v40, v49, v32
    v_fma_f32 v33, -v41, v49, v33
    v_fma_f32 v34, -v42, v49, v34
    v_fma_f32 v35, -v43, v49, v35
    v_fma_f32 v36, -v44, v49, v36
    v_fma_f32 v37, -v45, v49, v37
    v_fma_f32 v38, -v46, v49, v38
    v_fma_f32 v39, -v47, v49, v39
    v_fmac_f32 v40, v32, v50
    v_fmac_f32 v41, v33, v50
    v_fmac_f32 v42, v34, v50
    v_fmac_f32 v43, v35, v50
    v_fmac_f32 v44, v36, v50
    v_fmac_f32 v45, v37, v50
    v_fmac_f32 v46, v38, v50
    v_fmac_f32 v47, v39, v50
    v_cvt_pk_bf16_f32 v8, v40, v41
    v_cvt_pk_bf16_f32 v9, v42, v43
    v_cvt_pk_bf16_f32 v10, v44, v45
    v_cvt_pk_bf16_f32 v11, v46, v47
    s_cmp_lg_u32 s3, 0
    s_cbranch_scc1 L_skip_1
    s_getpc_b64 s[68:69]
L_pc:
    s_and_b32 s70, s68, 0xfff
    s_and_b32 s68, s68, 0xfffff000
    s_add_u32 s70, s70, L_codeend-L_pc-4
    v_lshrrev_b32 v27, 2, v1
    v_lshlrev_b32 v27, 12, v27
    v_and_b32 v28, 3, v1
    v_lshl_add_u32 v27, v28, 7, v27
    v_add_u32 v27, 0x1000, v27
    v_mov_b32 v13, s69
    v_add_co_u32 v12, vcc, s68, v27
    s_nop 1
    v_addc_co_u32 v13, vcc, 0, v13, vcc
    v_cmp_gt_u32 vcc, s70, v27
    s_nop 0
    s_and_b64 exec, exec, vcc
    s_cbranch_execz L_pfx
    global_load_dword v25, v[12:13], off
L_pfx:
    s_mov_b64 exec, -1
L_skip_1:
    s_add_u32 s73, s72, 65536
    s_waitcnt vmcnt(8)
    buffer_load_dwordx4 a[36:39], v3, s[28:31], s73 offen offset:1024 nt
    s_add_u32 s73, s79, 14336
    s_waitcnt vmcnt(6)
    buffer_load_dwordx4 v[168:171], v5, s[44:47], s73 offen nt
    s_waitcnt vmcnt(6)
    v_perm_b32 v32, v132, v128, s82
    v_perm_b32 v33, v140, v136, s82
    v_perm_b32 v34, v148, v144, s82
    v_perm_b32 v35, v156, v152, s82
    v_perm_b32 v36, v132, v128, s83
    v_perm_b32 v37, v140, v136, s83
    v_perm_b32 v38, v148, v144, s83
    v_perm_b32 v39, v156, v152, s83
    v_mfma_f32_16x16x32_bf16 v[64:67], v[8:11], v[32:35], 0
    v_perm_b32 v40, v133, v129, s82
    v_perm_b32 v41, v141, v137, s82
    v_perm_b32 v42, v149, v145, s82
    v_perm_b32 v43, v157, v153, s82
    v_mfma_f32_16x16x32_bf16 v[68:71], v[8:11], v[36:39], 0
    v_perm_b32 v44, v133, v129, s83
    v_perm_b32 v45, v141, v137, s83
    v_perm_b32 v46, v149, v145, s83
    v_perm_b32 v47, v157, v153, s83
    v_mfma_f32_16x16x32_bf16 v[72:75], v[8:11], v[40:43], 0
    v_perm_b32 v48, v134, v130, s82
    v_perm_b32 v49, v142, v138, s82
    v_perm_b32 v50, v150, v146, s82
    v_perm_b32 v51, v158, v154, s82
    v_mfma_f32_16x16x32_bf16 v[76:79], v[8:11], v[44:47], 0
    s_add_u32 s73, s72, 65536
    buffer_load_dwordx4 a[40:43], v3, s[28:31], s73 offen offset:2048 nt
    v_perm_b32 v52, v134, v130, s83
    v_perm_b32 v53, v142, v138, s83
    v_perm_b32 v54, v150, v146, s83
    v_perm_b32 v55, v158, v154, s83
    v_mfma_f32_16x16x32_bf16 v[80:83], v[8:11], v[48:51], 0
    v_perm_b32 v56, v135, v131, s82
    v_perm_b32 v57, v143, v139, s82
    v_perm_b32 v58, v151, v147, s82
    v_perm_b32 v59, v159, v155, s82
    v_mfma_f32_16x16x32_bf16 v[84:87], v[8:11], v[52:55], 0
    v_perm_b32 v60, v135, v131, s83
    v_perm_b32 v61, v143, v139, s83
    v_perm_b32 v62, v151, v147, s83
    v_perm_b32 v63, v159, v155, s83
    v_mfma_f32_16x16x32_bf16 v[88:91], v[8:11], v[56:59], 0
    s_nop 0
    v_mfma_f32_16x16x32_bf16 v[92:95], v[8:11], v[60:63], 0
    s_add_u32 s73, s79, 21504
    s_waitcnt vmcnt(6)
    buffer_load_dwordx4 v[172:175], v5, s[44:47], s73 offen nt
    v_add_f32_dpp v96, v65, v64 row_ror:8 row_mask:0xf bank_mask:0xf
    v_add_f32_dpp v97, v69, v68 row_ror:8 row_mask:0xf bank_mask:0xf
    v_add_f32_dpp v98, v73, v72 row_ror:8 row_mask:0xf bank_mask:0xf
    v_add_f32_dpp v99, v77, v76 row_ror:8 row_mask:0xf bank_mask:0xf
    v_add_f32_dpp v100, v81, v80 row_ror:8 row_mask:0xf bank_mask:0xf
    v_add_f32_dpp v101, v85, v84 row_ror:8 row_mask:0xf bank_mask:0xf
    v_add_f32_dpp v102, v89, v88 row_ror:8 row_mask:0xf bank_mask:0xf
    v_add_f32_dpp v103, v93, v92 row_ror:8 row_mask:0xf bank_mask:0xf
    s_mul_i32 s76, s3, 768
    s_add_u32 s76, s76, 0
    v_lshl_add_u32 v27, v1, 5, s76
    s_mov_b64 exec, 0xff
    ds_write_b128 v27, v[96:99]
    ds_write_b128 v27, v[100:103] offset:16
    s_mov_b64 exec, -1
    v_add_u32 v127, 1, v127
    s_nop 0
    v_readfirstlane_b32 s4, v127
    s_nop 0
    s_and_b32 s5, s4, 0xff
    s_waitcnt lgkmcnt(0)
    s_barrier
    s_cmp_lg_u32 s3, 0
    s_cbranch_scc1 L_skip_2
    s_mov_b64 exec, 0xffff
    ds_read_b128 v[32:35], v2 offset:0
    ds_read_b128 v[36:39], v2 offset:768
    ds_read_b128 v[40:43], v2 offset:1536
    ds_read_b128 v[44:47], v2 offset:2304
    s_lshr_b32 s76, s96, 1
    s_lshl_b32 s76, s76, 10
    s_and_b32 s96, s96, 1
    s_lshl_b32 s96, s96, 8
    s_add_u32 s96, s96, s76
    s_mul_i32 s76, s98, 32768
    s_add_u32 s96, s96, s76
    s_waitcnt lgkmcnt(0)
    v_add_f32 v32, v32, v36
    v_add_f32 v40, v40, v44
    v_add_f32 v33, v33, v37
    v_add_f32 v41, v41, v45
    v_add_f32 v34, v34, v38
    v_add_f32 v42, v42, v46
    v_add_f32 v35, v35, v39
    v_add_f32 v43, v43, v47
    v_add_f32 v32, v32, v40
    v_add_f32 v33, v33, v41
    v_add_f32 v34, v34, v42
    v_add_f32 v35, v35, v43
    v_add_u32 v32, 0x80, v32
    v_and_b32 v32, s6, v32
    v_or_b32 v32, s5, v32
    v_add_u32 v33, 0x80, v33
    v_and_b32 v33, s6, v33
    v_or_b32 v33, s5, v33
    v_add_u32 v34, 0x80, v34
    v_and_b32 v34, s6, v34
    v_or_b32 v34, s5, v34
    v_add_u32 v35, 0x80, v35
    v_and_b32 v35, s6, v35
    v_or_b32 v35, s5, v35
    buffer_store_dwordx4 v[32:35], v2, s[56:59], s96 offen offset:512 sc1
    s_mov_b64 exec, -1
L_skip_2:
    s_add_u32 s73, s72, 65536
    s_waitcnt vmcnt(6)
    buffer_load_dwordx4 a[44:47], v3, s[28:31], s73 offen offset:3072 nt
    s_add_u32 s73, s79, 28672
    s_waitcnt vmcnt(6)
    buffer_load_dwordx4 v[176:179], v5, s[44:47], s73 offen nt
    s_add_u32 s73, s72, 589824
    s_waitcnt vmcnt(6)
    buffer_load_dwordx4 a[48:51], v3, s[28:31], s73 offen nt
    s_add_u32 s73, s79, 35840
    s_waitcnt vmcnt(6)
    buffer_load_dwordx4 v[180:183], v5, s[44:47], s73 offen nt
    s_add_u32 s73, s72, 589824
    s_waitcnt vmcnt(6)
    buffer_load_dwordx4 a[52:55], v3, s[28:31], s73 offen offset:1024 nt
    s_add_u32 s73, s79, 43008
    s_waitcnt vmcnt(6)
    buffer_load_dwordx4 v[184:187], v5, s[44:47], s73 offen nt
    s_add_u32 s73, s72, 589824
    s_waitcnt vmcnt(6)
    buffer_load_dwordx4 a[56:59], v3, s[28:31], s73 offen offset:2048 nt
    s_add_u32 s73, s79, 50176
    s_waitcnt vmcnt(6)
    buffer_load_dwordx4 v[188:191], v5, s[44:47], s73 offen nt
    s_add_u32 s73, s72, 589824
    s_waitcnt vmcnt(6)
    buffer_load_dwordx4 a[60:63], v3, s[28:31], s73 offen offset:3072 nt
    s_add_u32 s73, s95, 0
    s_waitcnt vmcnt(6)
    buffer_load_dwordx4 v[192:195], v5, s[48:51], s73 offen nt
    s_add_u32 s73, s72, 4194304
    s_waitcnt vmcnt(6)
    buffer_load_dwordx4 a[64:67], v3, s[28:31], s73 offen nt
    s_add_u32 s73, s95, 7168
    s_waitcnt vmcnt(6)
    buffer_load_dwordx4 v[196:199], v5, s[48:51], s73 offen nt
    s_add_u32 s73, s72, 4194304
    s_waitcnt vmcnt(6)
    buffer_load_dwordx4 a[68:71], v3, s[28:31], s73 offen offset:1024 nt
    s_add_u32 s73, s95, 14336
    s_waitcnt vmcnt(6)
    buffer_load_dwordx4 v[200:203], v5, s[48:51], s73 offen nt
    s_waitcnt vmcnt(6)
    v_perm_b32 v32, v164, v160, s82
    v_perm_b32 v33, v172, v168, s82
    v_perm_b32 v34, v180, v176, s82
    v_perm_b32 v35, v188, v184, s82
    v_perm_b32 v36, v164, v160, s83
    v_perm_b32 v37, v172, v168, s83
    v_perm_b32 v38, v180, v176, s83
    v_perm_b32 v39, v188, v184, s83
    v_mfma_f32_16x16x32_bf16 v[64:67], v[8:11], v[32:35], 0
    v_perm_b32 v40, v165, v161, s82
    v_perm_b32 v41, v173, v169, s82
    v_perm_b32 v42, v181, v177, s82
    v_perm_b32 v43, v189, v185, s82
    v_mfma_f32_16x16x32_bf16 v[68:71], v[8:11], v[36:39], 0
    v_perm_b32 v44, v165, v161, s83
    v_perm_b32 v45, v173, v169, s83
    v_perm_b32 v46, v181, v177, s83
    v_perm_b32 v47, v189, v185, s83
    v_mfma_f32_16x16x32_bf16 v[72:75], v[8:11], v[40:43], 0
    v_perm_b32 v48, v166, v162, s82
    v_perm_b32 v49, v174, v170, s82
    v_perm_b32 v50, v182, v178, s82
    v_perm_b32 v51, v190, v186, s82
    v_mfma_f32_16x16x32_bf16 v[76:79], v[8:11], v[44:47], 0
    s_add_u32 s73, s72, 4194304
    buffer_load_dwordx4 a[72:75], v3, s[28:31], s73 offen offset:2048 nt
    v_perm_b32 v52, v166, v162, s83
    v_perm_b32 v53, v174, v170, s83
    v_perm_b32 v54, v182, v178, s83
    v_perm_b32 v55, v190, v186, s83
    v_mfma_f32_16x16x32_bf16 v[80:83], v[8:11], v[48:51], 0
    v_perm_b32 v56, v167, v163, s82
    v_perm_b32 v57, v175, v171, s82
    v_perm_b32 v58, v183, v179, s82
    v_perm_b32 v59, v191, v187, s82
    v_mfma_f32_16x16x32_bf16 v[84:87], v[8:11], v[52:55], 0
    v_perm_b32 v60, v167, v163, s83
    v_perm_b32 v61, v175, v171, s83
    v_perm_b32 v62, v183, v179, s83
    v_perm_b32 v63, v191, v187, s83
    v_mfma_f32_16x16x32_bf16 v[88:91], v[8:11], v[56:59], 0
    s_nop 0
    v_mfma_f32_16x16x32_bf16 v[92:95], v[8:11], v[60:63], 0
    s_add_u32 s73, s95, 21504
    s_waitcnt vmcnt(6)
    buffer_load_dwordx4 v[204:207], v5, s[48:51], s73 offen nt
    v_add_f32_dpp v96, v65, v64 row_ror:8 row_mask:0xf bank_mask:0xf
    v_add_f32_dpp v97, v69, v68 row_ror:8 row_mask:0xf bank_mask:0xf
    v_add_f32_dpp v98, v73, v72 row_ror:8 row_mask:0xf bank_mask:0xf
    v_add_f32_dpp v99, v77, v76 row_ror:8 row_mask:0xf bank_mask:0xf
    v_add_f32_dpp v100, v81, v80 row_ror:8 row_mask:0xf bank_mask:0xf
    v_add_f32_dpp v101, v85, v84 row_ror:8 row_mask:0xf bank_mask:0xf
    v_add_f32_dpp v102, v89, v88 row_ror:8 row_mask:0xf bank_mask:0xf
    v_add_f32_dpp v103, v93, v92 row_ror:8 row_mask:0xf bank_mask:0xf
    s_mul_i32 s76, s3, 768
    s_add_u32 s76, s76, 256
    v_lshl_add_u32 v27, v1, 5, s76
    s_mov_b64 exec, 0xff
    ds_write_b128 v27, v[96:99]
    ds_write_b128 v27, v[100:103] offset:16
    s_mov_b64 exec, -1
    s_add_u32 s73, s72, 4194304
    s_waitcnt vmcnt(6)
    buffer_load_dwordx4 a[76:79], v3, s[28:31], s73 offen offset:3072 nt
    s_add_u32 s73, s95, 28672
    s_waitcnt vmcnt(6)
    buffer_load_dwordx4 v[208:211], v5, s[48:51], s73 offen nt
    s_add_u32 s73, s72, 4718592
    s_waitcnt vmcnt(6)
    buffer_load_dwordx4 a[80:83], v3, s[28:31], s73 offen nt
    s_add_u32 s73, s95, 35840
    s_waitcnt vmcnt(6)
    buffer_load_dwordx4 v[212:215], v5, s[48:51], s73 offen nt
    s_add_u32 s73, s72, 4718592
    s_waitcnt vmcnt(6)
    buffer_load_dwordx4 a[84:87], v3, s[28:31], s73 offen offset:1024 nt
    s_add_u32 s73, s95, 43008
    s_waitcnt vmcnt(6)
    buffer_load_dwordx4 v[216:219], v5, s[48:51], s73 offen nt
    s_add_u32 s73, s72, 4718592
    s_waitcnt vmcnt(6)
    buffer_load_dwordx4 a[88:91], v3, s[28:31], s73 offen offset:2048 nt
    s_add_u32 s73, s95, 50176
    s_waitcnt vmcnt(6)
    buffer_load_dwordx4 v[220:223], v5, s[48:51], s73 offen nt
    s_add_u32 s73, s72, 4718592
    s_waitcnt vmcnt(6)
    buffer_load_dwordx4 a[92:95], v3, s[28:31], s73 offen offset:3072 nt
    s_add_u32 s73, s72, 4259840
    s_waitcnt vmcnt(6)
    buffer_load_dwordx4 a[96:99], v3, s[28:31], s73 offen nt
    s_waitcnt vmcnt(6)
    buffer_load_dwordx4 a[100:103], v3, s[28:31], s73 offen offset:1024 nt
    s_waitcnt vmcnt(6)
    buffer_load_dwordx4 a[104:107], v3, s[28:31], s73 offen offset:2048 nt
    s_waitcnt vmcnt(6)
    buffer_load_dwordx4 a[108:111], v3, s[28:31], s73 offen offset:3072 nt
    s_add_u32 s73, s72, 4784128
    s_waitcnt vmcnt(6)
    buffer_load_dwordx4 a[112:115], v3, s[28:31], s73 offen nt
    s_waitcnt vmcnt(6)
    v_perm_b32 v32, v196, v192, s82
    v_perm_b32 v33, v204, v200, s82
    v_perm_b32 v34, v212, v208, s82
    v_perm_b32 v35, v220, v216, s82
    v_perm_b32 v36, v196, v192, s83
    v_perm_b32 v37, v204, v200, s83
    v_perm_b32 v38, v212, v208, s83
    v_perm_b32 v39, v220, v216, s83
    v_mfma_f32_16x16x32_bf16 v[64:67], v[8:11], v[32:35], 0
    v_perm_b32 v40, v197, v193, s82
    v_perm_b32 v41, v205, v201, s82
    v_perm_b32 v42, v213, v209, s82
    v_perm_b32 v43, v221, v217, s82
    v_mfma_f32_16x16x32_bf16 v[68:71], v[8:11], v[36:39], 0
    v_perm_b32 v44, v197, v193, s83
    v_perm_b32 v45, v205, v201, s83
    v_perm_b32 v46, v213, v209, s83
    v_perm_b32 v47, v221, v217, s83
    v_mfma_f32_16x16x32_bf16 v[72:75], v[8:11], v[40:43], 0
    v_perm_b32 v48, v198, v194, s82
    v_perm_b32 v49, v206, v202, s82
    v_perm_b32 v50, v214, v210, s82
    v_perm_b32 v51, v222, v218, s82
    v_mfma_f32_16x16x32_bf16 v[76:79], v[8:11], v[44:47], 0
    buffer_load_dwordx4 a[116:119], v3, s[28:31], s73 offen offset:1024 nt
    v_perm_b32 v52, v198, v194, s83
    v_perm_b32 v53, v206, v202, s83
    v_perm_b32 v54, v214, v210, s83
    v_perm_b32 v55, v222, v218, s83
    v_mfma_f32_16x16x32_bf16 v[80:83], v[8:11], v[48:51], 0
    v_perm_b32 v56, v199, v195, s82
    v_perm_b32 v57, v207, v203, s82
    v_perm_b32 v58, v215, v211, s82
    v_perm_b32 v59, v223, v219, s82
    v_mfma_f32_16x16x32_bf16 v[84:87], v[8:11], v[52:55], 0
    v_perm_b32 v60, v199, v195, s83
    v_perm_b32 v61, v207, v203, s83
    v_perm_b32 v62, v215, v211, s83
    v_perm_b32 v63, v223, v219, s83
    v_mfma_f32_16x16x32_bf16 v[88:91], v[8:11], v[56:59], 0
    s_nop 0
    v_mfma_f32_16x16x32_bf16 v[92:95], v[8:11], v[60:63], 0
    s_waitcnt vmcnt(6)
    buffer_load_dwordx4 a[120:123], v3, s[28:31], s73 offen offset:2048 nt
    v_add_f32_dpp v96, v65, v64 row_ror:8 row_mask:0xf bank_mask:0xf
    v_add_f32_dpp v97, v69, v68 row_ror:8 row_mask:0xf bank_mask:0xf
    v_add_f32_dpp v98, v73, v72 row_ror:8 row_mask:0xf bank_mask:0xf
    v_add_f32_dpp v99, v77, v76 row_ror:8 row_mask:0xf bank_mask:0xf
    v_add_f32_dpp v100, v81, v80 row_ror:8 row_mask:0xf bank_mask:0xf
    v_add_f32_dpp v101, v85, v84 row_ror:8 row_mask:0xf bank_mask:0xf
    v_add_f32_dpp v102, v89, v88 row_ror:8 row_mask:0xf bank_mask:0xf
    v_add_f32_dpp v103, v93, v92 row_ror:8 row_mask:0xf bank_mask:0xf
    s_mul_i32 s76, s3, 768
    s_add_u32 s76, s76, 512
    v_lshl_add_u32 v27, v1, 5, s76
    s_mov_b64 exec, 0xff
    ds_write_b128 v27, v[96:99]
    ds_write_b128 v27, v[100:103] offset:16
    s_mov_b64 exec, -1
    v_mov_b32 v5, s5
    s_waitcnt lgkmcnt(0)
    s_barrier
    s_xor_b32 s92, s3, 0
    s_cmp_ge_u32 s99, 56
    s_cselect_b32 s92, 1, s92
    s_cmp_lg_u32 s92, 0
    s_cbranch_scc1 L_skip_3
    s_mov_b32 exec_hi, 0
    ds_read_b128 v[32:35], v2 offset:256
    ds_read_b128 v[36:39], v2 offset:1024
    ds_read_b128 v[40:43], v2 offset:1792
    ds_read_b128 v[44:47], v2 offset:2560
    s_lshr_b32 s76, s99, 1
    s_lshl_b32 s76, s76, 10
    s_and_b32 s77, s99, 1
    s_lshl_b32 s77, s77, 8
    s_add_u32 s77, s77, s76
    s_mul_i32 s76, s98, 28672
    s_add_u32 s77, s77, s76
    s_lshr_b32 s76, s97, 1
    s_lshl_b32 s76, s76, 10
    s_and_b32 s97, s97, 1
    s_lshl_b32 s97, s97, 8
    s_add_u32 s97, s97, s76
    s_mul_i32 s76, s98, 28672
    s_add_u32 s97, s97, s76
    s_add_u32 s97, s97, 130816
    s_sub_u32 s97, s97, s77
    v_mul_lo_u32 v27, v31, s97
    v_add_u32 v27, v27, v2
    s_add_u32 s77, s77, 131584
    s_waitcnt lgkmcnt(0)
    v_add_f32 v32, v32, v36
    v_add_f32 v40, v40, v44
    v_add_f32 v33, v33, v37
    v_add_f32 v41, v41, v45
    v_add_f32 v34, v34, v38
    v_add_f32 v42, v42, v46
    v_add_f32 v35, v35, v39
    v_add_f32 v43, v43, v47
    v_add_f32 v32, v32, v40
    v_add_f32 v33, v33, v41
    v_add_f32 v34, v34, v42
    v_add_f32 v35, v35, v43
    v_add_u32 v32, 0x80, v32
    v_and_or_b32 v32, v32, s6, v5
    v_add_u32 v33, 0x80, v33
    v_and_or_b32 v33, v33, s6, v5
    v_add_u32 v34, 0x80, v34
    v_and_or_b32 v34, v34, s6, v5
    v_add_u32 v35, 0x80, v35
    v_and_or_b32 v35, v35, s6, v5
    buffer_store_dwordx4 v[32:35], v27, s[56:59], s77 offen sc1
    s_mov_b64 exec, -1
L_skip_3:
    s_waitcnt vmcnt(6)
    buffer_load_dwordx4 a[124:127], v3, s[28:31], s73 offen offset:3072 nt
    s_add_u32 s73, s72, 8388608
    s_waitcnt vmcnt(6)
    buffer_load_dwordx4 a[128:131], v3, s[28:31], s73 offen nt
    s_waitcnt vmcnt(6)
    buffer_load_dwordx4 a[132:135], v3, s[28:31], s73 offen offset:1024 nt
    s_waitcnt vmcnt(6)
    buffer_load_dwordx4 a[136:139], v3, s[28:31], s73 offen offset:2048 nt
    s_waitcnt vmcnt(6)
    buffer_load_dwordx4 a[140:143], v3, s[28:31], s73 offen offset:3072 nt
    s_add_u32 s73, s72, 8912896
    s_waitcnt vmcnt(6)
    buffer_load_dwordx4 a[144:147], v3, s[28:31], s73 offen nt
    v_and_b32 v248, 32, v1
    v_lshl_add_u32 v248, v248, 4, v2
    s_lshl_b32 s76, s74, 13
    s_lshl_b32 s77, s3, 11
    s_add_u32 s10, s76, s77
    s_add_u32 s11, s10, 32768
    s_add_u32 s12, s10, 65536
    s_add_u32 s13, s10, 98304
    buffer_load_dwordx4 v[224:227], v248, s[56:59], s10 offen offset:512 sc1
    buffer_load_dwordx4 v[228:231], v248, s[56:59], s11 offen offset:512 sc1
    buffer_load_dwordx4 v[232:235], v248, s[56:59], s12 offen offset:512 sc1
    buffer_load_dwordx4 v[236:239], v248, s[56:59], s13 offen offset:512 sc1
    s_waitcnt vmcnt(10)
    buffer_load_dwordx4 a[148:151], v3, s[28:31], s73 offen offset:1024 nt
    s_waitcnt vmcnt(10)
    buffer_load_dwordx4 a[152:155], v3, s[28:31], s73 offen offset:2048 nt
    s_waitcnt vmcnt(10)
    buffer_load_dwordx4 a[156:159], v3, s[28:31], s73 offen offset:3072 nt
    s_add_u32 s73, s72, 8454144
    s_waitcnt vmcnt(10)
    buffer_load_dwordx4 a[160:163], v3, s[28:31], s73 offen nt
    s_waitcnt vmcnt(10)
    buffer_load_dwordx4 a[164:167], v3, s[28:31], s73 offen offset:1024 nt
    s_waitcnt vmcnt(10)
    buffer_load_dwordx4 a[168:171], v3, s[28:31], s73 offen offset:2048 nt
    s_waitcnt vmcnt(6)
    v_xor_b32 v224, v5, v224
    v_xor_b32 v225, v5, v225
    v_xor_b32 v226, v5, v226
    v_xor_b32 v227, v5, v227
    v_xor_b32 v228, v5, v228
    v_xor_b32 v229, v5, v229
    v_xor_b32 v230, v5, v230
    v_xor_b32 v231, v5, v231
    v_xor_b32 v232, v5, v232
    v_xor_b32 v233, v5, v233
    v_xor_b32 v234, v5, v234
    v_xor_b32 v235, v5, v235
    v_xor_b32 v236, v5, v236
    v_xor_b32 v237, v5, v237
    v_xor_b32 v238, v5, v238
    v_xor_b32 v239, v5, v239
    v_or3_b32 v27, v224, v225, v226
    v_or3_b32 v27, v27, v227, v228
    v_or3_b32 v27, v27, v229, v230
    v_or3_b32 v27, v27, v231, v232
    v_or3_b32 v27, v27, v233, v234
    v_or3_b32 v27, v27, v235, v236
    v_or3_b32 v27, v27, v237, v238
    v_or_b32 v27, v27, v239
    v_and_b32 v27, 0xff, v27
    v_cmp_ne_u32 vcc, 0, v27
    s_cbranch_vccnz L_q_retry_4
L_q_ok_5:
    buffer_load_dwordx4 a[172:175], v3, s[28:31], s73 offen offset:3072 nt
    v_add_f32 v224, v224, v228
    v_add_f32 v232, v232, v236
    v_add_f32 v225, v225, v229
    v_add_f32 v233, v233, v237
    v_add_f32 v226, v226, v230
    v_add_f32 v234, v234, v238
    v_add_f32 v227, v227, v231
    v_add_f32 v235, v235, v239
    v_add_f32 v224, v224, v232
    v_add_f32 v225, v225, v233
    v_add_f32 v226, v226, v234
    v_add_f32 v227, v227, v235
    v_cvt_pk_bf16_f32 v228, v224, v225
    v_cvt_pk_bf16_f32 v229, v226, v227
    s_lshl_b32 s76, s3, 9
    s_add_u32 s76, s76, 3072
    v_lshl_add_u32 v27, v1, 3, s76
    ds_write_b64 v27, v[228:229]
    s_waitcnt lgkmcnt(0)
    s_barrier
    v_and_b32 v27, 7, v1
    v_lshlrev_b32 v27, 8, v27
    v_lshl_add_u32 v27, v31, 6, v27
    v_and_b32 v28, 8, v1
    v_lshl_add_u32 v27, v28, 1, v27
    ds_read_b128 v[16:19], v27 offset:3072
    ds_read_b128 v[20:23], v27 offset:3104
    v_mov_b32 v24, 0xff800000
    s_waitcnt lgkmcnt(0)
    s_add_u32 s73, s72, 8978432
    s_waitcnt vmcnt(6)
    buffer_load_dwordx4 a[176:179], v3, s[28:31], s73 offen nt
    v_mfma_f32_16x16x32_bf16 v[32:35], a[0:3], v[16:19], 0
    v_mfma_f32_16x16x32_bf16 v[36:39], a[0:3], v[20:23], 0
    v_mfma_f32_16x16x32_bf16 v[40:43], a[4:7], v[16:19], 0
    v_mfma_f32_16x16x32_bf16 v[44:47], a[4:7], v[20:23], 0
    v_mfma_f32_16x16x32_bf16 v[48:51], a[8:11], v[16:19], 0
    v_mfma_f32_16x16x32_bf16 v[52:55], a[8:11], v[20:23], 0
    v_mfma_f32_16x16x32_bf16 v[56:59], a[12:15], v[16:19], 0
    v_mfma_f32_16x16x32_bf16 v[60:63], a[12:15], v[20:23], 0
    s_nop 1
    v_add_f32 v33, v33, v39
    v_add_f32 v32, v32, v38
    v_add_f32 v41, v41, v47
    v_add_f32 v40, v40, v46
    v_add_f32 v49, v49, v55
    v_add_f32 v48, v48, v54
    v_add_f32 v57, v57, v63
    v_add_f32 v56, v56, v62
    v_add_f32_dpp v64, v33, v32 row_ror:8 row_mask:0xf bank_mask:0xf
    v_add_f32_dpp v65, v41, v40 row_ror:8 row_mask:0xf bank_mask:0xf
    v_add_f32_dpp v66, v49, v48 row_ror:8 row_mask:0xf bank_mask:0xf
    v_add_f32_dpp v67, v57, v56 row_ror:8 row_mask:0xf bank_mask:0xf
    s_waitcnt vmcnt(6)
    buffer_load_dwordx4 a[180:183], v3, s[28:31], s73 offen offset:1024 nt
    v_mfma_f32_16x16x32_bf16 v[32:35], a[16:19], v[16:19], 0
    v_mfma_f32_16x16x32_bf16 v[36:39], a[16:19], v[20:23], 0
    v_mfma_f32_16x16x32_bf16 v[40:43], a[20:23], v[16:19], 0
    v_mfma_f32_16x16x32_bf16 v[44:47], a[20:23], v[20:23], 0
    v_mfma_f32_16x16x32_bf16 v[48:51], a[24:27], v[16:19], 0
    v_mfma_f32_16x16x32_bf16 v[52:55], a[24:27], v[20:23], 0
    v_mfma_f32_16x16x32_bf16 v[56:59], a[28:31], v[16:19], 0
    v_mfma_f32_16x16x32_bf16 v[60:63], a[28:31], v[20:23], 0
    s_nop 1
    v_add_f32 v33, v33, v39
    v_add_f32 v32, v32, v38
    v_add_f32 v41, v41, v47
    v_add_f32 v40, v40, v46
    v_add_f32 v49, v49, v55
    v_add_f32 v48, v48, v54
    v_add_f32 v57, v57, v63
    v_add_f32 v56, v56, v62
    v_add_f32_dpp v68, v33, v32 row_ror:8 row_mask:0xf bank_mask:0xf
    v_add_f32_dpp v69, v41, v40 row_ror:8 row_mask:0xf bank_mask:0xf
    v_add_f32_dpp v70, v49, v48 row_ror:8 row_mask:0xf bank_mask:0xf
    v_add_f32_dpp v71, v57, v56 row_ror:8 row_mask:0xf bank_mask:0xf
    s_waitcnt vmcnt(6)
    buffer_load_dwordx4 a[184:187], v3, s[28:31], s73 offen offset:2048 nt
    v_cvt_pk_bf16_f32 v48, v64, v65
    v_cvt_pk_bf16_f32 v49, v66, v67
    v_cvt_pk_bf16_f32 v50, v68, v69
    v_cvt_pk_bf16_f32 v51, v70, v71
    v_lshlrev_b32 v64, 16, v48
    v_and_b32 v65, s86, v48
    v_lshlrev_b32 v66, 16, v49
    v_and_b32 v67, s86, v49
    v_lshlrev_b32 v68, 16, v50
    v_and_b32 v69, s86, v50
    v_lshlrev_b32 v70, 16, v51
    v_and_b32 v71, s86, v51
    v_mul_f32 v64, 0x3db504f3, v64
    v_mul_f32 v65, 0x3db504f3, v65
    v_mul_f32 v66, 0x3db504f3, v66
    v_mul_f32 v67, 0x3db504f3, v67
    v_mul_f32 v68, 0x3db504f3, v68
    v_mul_f32 v69, 0x3db504f3, v69
    v_mul_f32 v70, 0x3db504f3, v70
    v_mul_f32 v71, 0x3db504f3, v71
    v_cvt_pk_bf16_f32 v48, v64, v65
    v_cvt_pk_bf16_f32 v49, v66, v67
    v_cvt_pk_bf16_f32 v50, v68, v69
    v_cvt_pk_bf16_f32 v51, v70, v71
    v_lshlrev_b32 v64, 16, v48
    v_and_b32 v65, s86, v48
    v_lshlrev_b32 v66, 16, v49
    v_and_b32 v67, s86, v49
    v_lshlrev_b32 v68, 16, v50
    v_and_b32 v69, s86, v50
    v_lshlrev_b32 v70, 16, v51
    v_and_b32 v71, s86, v51
    v_max3_f32 v24, v24, v64, v65
    v_max3_f32 v24, v24, v66, v67
    v_max3_f32 v24, v24, v68, v69
    v_max3_f32 v24, v24, v70, v71
    v_mfma_f32_16x16x32_bf16 v[32:35], a[32:35], v[16:19], 0
    v_mfma_f32_16x16x32_bf16 v[36:39], a[32:35], v[20:23], 0
    v_mfma_f32_16x16x32_bf16 v[40:43], a[36:39], v[16:19], 0
    v_mfma_f32_16x16x32_bf16 v[44:47], a[36:39], v[20:23], 0
    v_mfma_f32_16x16x32_bf16 v[48:51], a[40:43], v[16:19], 0
    v_mfma_f32_16x16x32_bf16 v[52:55], a[40:43], v[20:23], 0
    v_mfma_f32_16x16x32_bf16 v[56:59], a[44:47], v[16:19], 0
    v_mfma_f32_16x16x32_bf16 v[60:63], a[44:47], v[20:23], 0
    s_nop 1
    v_add_f32 v33, v33, v39
    v_add_f32 v32, v32, v38
    v_add_f32 v41, v41, v47
    v_add_f32 v40, v40, v46
    v_add_f32 v49, v49, v55
    v_add_f32 v48, v48, v54
    v_add_f32 v57, v57, v63
    v_add_f32 v56, v56, v62
    v_add_f32_dpp v72, v33, v32 row_ror:8 row_mask:0xf bank_mask:0xf
    v_add_f32_dpp v73, v41, v40 row_ror:8 row_mask:0xf bank_mask:0xf
    v_add_f32_dpp v74, v49, v48 row_ror:8 row_mask:0xf bank_mask:0xf
    v_add_f32_dpp v75, v57, v56 row_ror:8 row_mask:0xf bank_mask:0xf
    s_waitcnt vmcnt(6)
    buffer_load_dwordx4 a[188:191], v3, s[28:31], s73 offen offset:3072 nt
    v_mfma_f32_16x16x32_bf16 v[32:35], a[48:51], v[16:19], 0
    v_mfma_f32_16x16x32_bf16 v[36:39], a[48:51], v[20:23], 0
    v_mfma_f32_16x16x32_bf16 v[40:43], a[52:55], v[16:19], 0
    v_mfma_f32_16x16x32_bf16 v[44:47], a[52:55], v[20:23], 0
    v_mfma_f32_16x16x32_bf16 v[48:51], a[56:59], v[16:19], 0
    v_mfma_f32_16x16x32_bf16 v[52:55], a[56:59], v[20:23], 0
    v_mfma_f32_16x16x32_bf16 v[56:59], a[60:63], v[16:19], 0
    v_mfma_f32_16x16x32_bf16 v[60:63], a[60:63], v[20:23], 0
    s_nop 1
    v_add_f32 v33, v33, v39
    v_add_f32 v32, v32, v38
    v_add_f32 v41, v41, v47
    v_add_f32 v40, v40, v46
    v_add_f32 v49, v49, v55
    v_add_f32 v48, v48, v54
    v_add_f32 v57, v57, v63
    v_add_f32 v56, v56, v62
    v_add_f32_dpp v76, v33, v32 row_ror:8 row_mask:0xf bank_mask:0xf
    v_add_f32_dpp v77, v41, v40 row_ror:8 row_mask:0xf bank_mask:0xf
    v_add_f32_dpp v78, v49, v48 row_ror:8 row_mask:0xf bank_mask:0xf
    v_add_f32_dpp v79, v57, v56 row_ror:8 row_mask:0xf bank_mask:0xf
    s_add_u32 s73, s72, 12582912
    s_waitcnt vmcnt(6)
    buffer_load_dwordx4 a[192:195], v3, s[28:31], s73 offen nt
    v_cvt_pk_bf16_f32 v48, v72, v73
    v_cvt_pk_bf16_f32 v49, v74, v75
    v_cvt_pk_bf16_f32 v50, v76, v77
    v_cvt_pk_bf16_f32 v51, v78, v79
    v_lshlrev_b32 v72, 16, v48
    v_and_b32 v73, s86, v48
    v_lshlrev_b32 v74, 16, v49
    v_and_b32 v75, s86, v49
    v_lshlrev_b32 v76, 16, v50
    v_and_b32 v77, s86, v50
    v_lshlrev_b32 v78, 16, v51
    v_and_b32 v79, s86, v51
    v_mul_f32 v72, 0x3db504f3, v72
    v_mul_f32 v73, 0x3db504f3, v73
    v_mul_f32 v74, 0x3db504f3, v74
    v_mul_f32 v75, 0x3db504f3, v75
    v_mul_f32 v76, 0x3db504f3, v76
    v_mul_f32 v77, 0x3db504f3, v77
    v_mul_f32 v78, 0x3db504f3, v78
    v_mul_f32 v79, 0x3db504f3, v79
    v_cvt_pk_bf16_f32 v48, v72, v73
    v_cvt_pk_bf16_f32 v49, v74, v75
    v_cvt_pk_bf16_f32 v50, v76, v77
    v_cvt_pk_bf16_f32 v51, v78, v79
    v_lshlrev_b32 v72, 16, v48
    v_and_b32 v73, s86, v48
    v_lshlrev_b32 v74, 16, v49
    v_and_b32 v75, s86, v49
    v_lshlrev_b32 v76, 16, v50
    v_and_b32 v77, s86, v50
    v_lshlrev_b32 v78, 16, v51
    v_and_b32 v79, s86, v51
    v_max3_f32 v24, v24, v72, v73
    v_max3_f32 v24, v24, v74, v75
    v_max3_f32 v24, v24, v76, v77
    v_max3_f32 v24, v24, v78, v79
    v_mfma_f32_16x16x32_bf16 v[32:35], a[64:67], v[16:19], 0
    v_mfma_f32_16x16x32_bf16 v[36:39], a[64:67], v[20:23], 0
    v_mfma_f32_16x16x32_bf16 v[40:43], a[68:71], v[16:19], 0
    v_mfma_f32_16x16x32_bf16 v[44:47], a[68:71], v[20:23], 0
    v_mfma_f32_16x16x32_bf16 v[48:51], a[72:75], v[16:19], 0
    v_mfma_f32_16x16x32_bf16 v[52:55], a[72:75], v[20:23], 0
    v_mfma_f32_16x16x32_bf16 v[56:59], a[76:79], v[16:19], 0
    v_mfma_f32_16x16x32_bf16 v[60:63], a[76:79], v[20:23], 0
    s_nop 1
    v_add_f32 v33, v33, v39
    v_add_f32 v32, v32, v38
    v_add_f32 v41, v41, v47
    v_add_f32 v40, v40, v46
    v_add_f32 v49, v49, v55
    v_add_f32 v48, v48, v54
    v_add_f32 v57, v57, v63
    v_add_f32 v56, v56, v62
    v_add_f32_dpp v80, v33, v32 row_ror:8 row_mask:0xf bank_mask:0xf
    v_add_f32_dpp v81, v41, v40 row_ror:8 row_mask:0xf bank_mask:0xf
    v_add_f32_dpp v82, v49, v48 row_ror:8 row_mask:0xf bank_mask:0xf
    v_add_f32_dpp v83, v57, v56 row_ror:8 row_mask:0xf bank_mask:0xf
    s_waitcnt vmcnt(6)
    buffer_load_dwordx4 a[196:199], v3, s[28:31], s73 offen offset:1024 nt
    v_mfma_f32_16x16x32_bf16 v[32:35], a[80:83], v[16:19], 0
    v_mfma_f32_16x16x32_bf16 v[36:39], a[80:83], v[20:23], 0
    v_mfma_f32_16x16x32_bf16 v[40:43], a[84:87], v[16:19], 0
    v_mfma_f32_16x16x32_bf16 v[44:47], a[84:87], v[20:23], 0
    v_mfma_f32_16x16x32_bf16 v[48:51], a[88:91], v[16:19], 0
    v_mfma_f32_16x16x32_bf16 v[52:55], a[88:91], v[20:23], 0
    v_mfma_f32_16x16x32_bf16 v[56:59], a[92:95], v[16:19], 0
    v_mfma_f32_16x16x32_bf16 v[60:63], a[92:95], v[20:23], 0
    s_nop 1
    v_add_f32 v33, v33, v39
    v_add_f32 v32, v32, v38
    v_add_f32 v41, v41, v47
    v_add_f32 v40, v40, v46
    v_add_f32 v49, v49, v55
    v_add_f32 v48, v48, v54
    v_add_f32 v57, v57, v63
    v_add_f32 v56, v56, v62
    v_add_f32_dpp v84, v33, v32 row_ror:8 row_mask:0xf bank_mask:0xf
    v_add_f32_dpp v85, v41, v40 row_ror:8 row_mask:0xf bank_mask:0xf
    v_add_f32_dpp v86, v49, v48 row_ror:8 row_mask:0xf bank_mask:0xf
    v_add_f32_dpp v87, v57, v56 row_ror:8 row_mask:0xf bank_mask:0xf
    s_waitcnt vmcnt(6)
    buffer_load_dwordx4 a[200:203], v3, s[28:31], s73 offen offset:2048 nt
    v_cvt_pk_bf16_f32 v48, v80, v81
    v_cvt_pk_bf16_f32 v49, v82, v83
    v_cvt_pk_bf16_f32 v50, v84, v85
    v_cvt_pk_bf16_f32 v51, v86, v87
    v_lshlrev_b32 v80, 16, v48
    v_and_b32 v81, s86, v48
    v_lshlrev_b32 v82, 16, v49
    v_and_b32 v83, s86, v49
    v_lshlrev_b32 v84, 16, v50
    v_and_b32 v85, s86, v50
    v_lshlrev_b32 v86, 16, v51
    v_and_b32 v87, s86, v51
    v_mul_f32 v80, 0x3db504f3, v80
    v_mul_f32 v81, 0x3db504f3, v81
    v_mul_f32 v82, 0x3db504f3, v82
    v_mul_f32 v83, 0x3db504f3, v83
    v_mul_f32 v84, 0x3db504f3, v84
    v_mul_f32 v85, 0x3db504f3, v85
    v_mul_f32 v86, 0x3db504f3, v86
    v_mul_f32 v87, 0x3db504f3, v87
    v_cvt_pk_bf16_f32 v48, v80, v81
    v_cvt_pk_bf16_f32 v49, v82, v83
    v_cvt_pk_bf16_f32 v50, v84, v85
    v_cvt_pk_bf16_f32 v51, v86, v87
    v_lshlrev_b32 v80, 16, v48
    v_and_b32 v81, s86, v48
    v_lshlrev_b32 v82, 16, v49
    v_and_b32 v83, s86, v49
    v_lshlrev_b32 v84, 16, v50
    v_and_b32 v85, s86, v50
    v_lshlrev_b32 v86, 16, v51
    v_and_b32 v87, s86, v51
    v_max3_f32 v24, v24, v80, v81
    v_max3_f32 v24, v24, v82, v83
    v_max3_f32 v24, v24, v84, v85
    v_max3_f32 v24, v24, v86, v87
    v_mfma_f32_16x16x32_bf16 v[32:35], a[96:99], v[16:19], 0
    v_mfma_f32_16x16x32_bf16 v[36:39], a[96:99], v[20:23], 0
    v_mfma_f32_16x16x32_bf16 v[40:43], a[100:103], v[16:19], 0
    v_mfma_f32_16x16x32_bf16 v[44:47], a[100:103], v[20:23], 0
    v_mfma_f32_16x16x32_bf16 v[48:51], a[104:107], v[16:19], 0
    v_mfma_f32_16x16x32_bf16 v[52:55], a[104:107], v[20:23], 0
    v_mfma_f32_16x16x32_bf16 v[56:59], a[108:111], v[16:19], 0
    v_mfma_f32_16x16x32_bf16 v[60:63], a[108:111], v[20:23], 0
    s_nop 1
    v_add_f32 v33, v33, v39
    v_add_f32 v32, v32, v38
    v_add_f32 v41, v41, v47
    v_add_f32 v40, v40, v46
    v_add_f32 v49, v49, v55
    v_add_f32 v48, v48, v54
    v_add_f32 v57, v57, v63
    v_add_f32 v56, v56, v62
    v_add_f32_dpp v88, v33, v32 row_ror:8 row_mask:0xf bank_mask:0xf
    v_add_f32_dpp v89, v41, v40 row_ror:8 row_mask:0xf bank_mask:0xf
    v_add_f32_dpp v90, v49, v48 row_ror:8 row_mask:0xf bank_mask:0xf
    v_add_f32_dpp v91, v57, v56 row_ror:8 row_mask:0xf bank_mask:0xf
    s_waitcnt vmcnt(6)
    buffer_load_dwordx4 a[204:207], v3, s[28:31], s73 offen offset:3072 nt
    v_mfma_f32_16x16x32_bf16 v[32:35], a[112:115], v[16:19], 0
    v_mfma_f32_16x16x32_bf16 v[36:39], a[112:115], v[20:23], 0
    v_mfma_f32_16x16x32_bf16 v[40:43], a[116:119], v[16:19], 0
    v_mfma_f32_16x16x32_bf16 v[44:47], a[116:119], v[20:23], 0
    v_mfma_f32_16x16x32_bf16 v[48:51], a[120:123], v[16:19], 0
    v_mfma_f32_16x16x32_bf16 v[52:55], a[120:123], v[20:23], 0
    v_mfma_f32_16x16x32_bf16 v[56:59], a[124:127], v[16:19], 0
    v_mfma_f32_16x16x32_bf16 v[60:63], a[124:127], v[20:23], 0
    s_nop 1
    v_add_f32 v33, v33, v39
    v_add_f32 v32, v32, v38
    v_add_f32 v41, v41, v47
    v_add_f32 v40, v40, v46
    v_add_f32 v49, v49, v55
    v_add_f32 v48, v48, v54
    v_add_f32 v57, v57, v63
    v_add_f32 v56, v56, v62
    v_add_f32_dpp v92, v33, v32 row_ror:8 row_mask:0xf bank_mask:0xf
    v_add_f32_dpp v93, v41, v40 row_ror:8 row_mask:0xf bank_mask:0xf
    v_add_f32_dpp v94, v49, v48 row_ror:8 row_mask:0xf bank_mask:0xf
    v_add_f32_dpp v95, v57, v56 row_ror:8 row_mask:0xf bank_mask:0xf
    s_add_u32 s73, s72, 13107200
    s_waitcnt vmcnt(6)
    buffer_load_dwordx4 a[208:211], v3, s[28:31], s73 offen nt
    v_cvt_pk_bf16_f32 v48, v88, v89
    v_cvt_pk_bf16_f32 v49, v90, v91
    v_cvt_pk_bf16_f32 v50, v92, v93
    v_cvt_pk_bf16_f32 v51, v94, v95
    v_lshlrev_b32 v88, 16, v48
    v_and_b32 v89, s86, v48
    v_lshlrev_b32 v90, 16, v49
    v_and_b32 v91, s86, v49
    v_lshlrev_b32 v92, 16, v50
    v_and_b32 v93, s86, v50
    v_lshlrev_b32 v94, 16, v51
    v_and_b32 v95, s86, v51
    v_mul_f32 v88, 0x3db504f3, v88
    v_mul_f32 v89, 0x3db504f3, v89
    v_mul_f32 v90, 0x3db504f3, v90
    v_mul_f32 v91, 0x3db504f3, v91
    v_mul_f32 v92, 0x3db504f3, v92
    v_mul_f32 v93, 0x3db504f3, v93
    v_mul_f32 v94, 0x3db504f3, v94
    v_mul_f32 v95, 0x3db504f3, v95
    v_cvt_pk_bf16_f32 v48, v88, v89
    v_cvt_pk_bf16_f32 v49, v90, v91
    v_cvt_pk_bf16_f32 v50, v92, v93
    v_cvt_pk_bf16_f32 v51, v94, v95
    v_lshlrev_b32 v88, 16, v48
    v_and_b32 v89, s86, v48
    v_lshlrev_b32 v90, 16, v49
    v_and_b32 v91, s86, v49
    v_lshlrev_b32 v92, 16, v50
    v_and_b32 v93, s86, v50
    v_lshlrev_b32 v94, 16, v51
    v_and_b32 v95, s86, v51
    v_max3_f32 v24, v24, v88, v89
    v_max3_f32 v24, v24, v90, v91
    v_max3_f32 v24, v24, v92, v93
    v_max3_f32 v24, v24, v94, v95
    v_mfma_f32_16x16x32_bf16 v[32:35], a[128:131], v[16:19], 0
    v_mfma_f32_16x16x32_bf16 v[36:39], a[128:131], v[20:23], 0
    v_mfma_f32_16x16x32_bf16 v[40:43], a[132:135], v[16:19], 0
    v_mfma_f32_16x16x32_bf16 v[44:47], a[132:135], v[20:23], 0
    v_mfma_f32_16x16x32_bf16 v[48:51], a[136:139], v[16:19], 0
    v_mfma_f32_16x16x32_bf16 v[52:55], a[136:139], v[20:23], 0
    v_mfma_f32_16x16x32_bf16 v[56:59], a[140:143], v[16:19], 0
    v_mfma_f32_16x16x32_bf16 v[60:63], a[140:143], v[20:23], 0
    s_nop 1
    v_add_f32 v33, v33, v39
    v_add_f32 v32, v32, v38
    v_add_f32 v41, v41, v47
    v_add_f32 v40, v40, v46
    v_add_f32 v49, v49, v55
    v_add_f32 v48, v48, v54
    v_add_f32 v57, v57, v63
    v_add_f32 v56, v56, v62
    v_add_f32_dpp v96, v33, v32 row_ror:8 row_mask:0xf bank_mask:0xf
    v_add_f32_dpp v97, v41, v40 row_ror:8 row_mask:0xf bank_mask:0xf
    v_add_f32_dpp v98, v49, v48 row_ror:8 row_mask:0xf bank_mask:0xf
    v_add_f32_dpp v99, v57, v56 row_ror:8 row_mask:0xf bank_mask:0xf
    s_waitcnt vmcnt(6)
    buffer_load_dwordx4 a[212:215], v3, s[28:31], s73 offen offset:1024 nt
    v_mfma_f32_16x16x32_bf16 v[32:35], a[144:147], v[16:19], 0
    v_mfma_f32_16x16x32_bf16 v[36:39], a[144:147], v[20:23], 0
    v_mfma_f32_16x16x32_bf16 v[40:43], a[148:151], v[16:19], 0
    v_mfma_f32_16x16x32_bf16 v[44:47], a[148:151], v[20:23], 0
    v_mfma_f32_16x16x32_bf16 v[48:51], a[152:155], v[16:19], 0
    v_mfma_f32_16x16x32_bf16 v[52:55], a[152:155], v[20:23], 0
    v_mfma_f32_16x16x32_bf16 v[56:59], a[156:159], v[16:19], 0
    v_mfma_f32_16x16x32_bf16 v[60:63], a[156:159], v[20:23], 0
    s_nop 1
    v_add_f32 v33, v33, v39
    v_add_f32 v32, v32, v38
    v_add_f32 v41, v41, v47
    v_add_f32 v40, v40, v46
    v_add_f32 v49, v49, v55
    v_add_f32 v48, v48, v54
    v_add_f32 v57, v57, v63
    v_add_f32 v56, v56, v62
    v_add_f32_dpp v100, v33, v32 row_ror:8 row_mask:0xf bank_mask:0xf
    v_add_f32_dpp v101, v41, v40 row_ror:8 row_mask:0xf bank_mask:0xf
    v_add_f32_dpp v102, v49, v48 row_ror:8 row_mask:0xf bank_mask:0xf
    v_add_f32_dpp v103, v57, v56 row_ror:8 row_mask:0xf bank_mask:0xf
    s_waitcnt vmcnt(6)
    buffer_load_dwordx4 a[216:219], v3, s[28:31], s73 offen offset:2048 nt
    v_cvt_pk_bf16_f32 v48, v96, v97
    v_cvt_pk_bf16_f32 v49, v98, v99
    v_cvt_pk_bf16_f32 v50, v100, v101
    v_cvt_pk_bf16_f32 v51, v102, v103
    v_lshlrev_b32 v96, 16, v48
    v_and_b32 v97, s86, v48
    v_lshlrev_b32 v98, 16, v49
    v_and_b32 v99, s86, v49
    v_lshlrev_b32 v100, 16, v50
    v_and_b32 v101, s86, v50
    v_lshlrev_b32 v102, 16, v51
    v_and_b32 v103, s86, v51
    v_mul_f32 v96, 0x3db504f3, v96
    v_mul_f32 v97, 0x3db504f3, v97
    v_mul_f32 v98, 0x3db504f3, v98
    v_mul_f32 v99, 0x3db504f3, v99
    v_mul_f32 v100, 0x3db504f3, v100
    v_mul_f32 v101, 0x3db504f3, v101
    v_mul_f32 v102, 0x3db504f3, v102
    v_mul_f32 v103, 0x3db504f3, v103
    v_cvt_pk_bf16_f32 v48, v96, v97
    v_cvt_pk_bf16_f32 v49, v98, v99
    v_cvt_pk_bf16_f32 v50, v100, v101
    v_cvt_pk_bf16_f32 v51, v102, v103
    v_lshlrev_b32 v96, 16, v48
    v_and_b32 v97, s86, v48
    v_lshlrev_b32 v98, 16, v49
    v_and_b32 v99, s86, v49
    v_lshlrev_b32 v100, 16, v50
    v_and_b32 v101, s86, v50
    v_lshlrev_b32 v102, 16, v51
    v_and_b32 v103, s86, v51
    v_max3_f32 v24, v24, v96, v97
    v_max3_f32 v24, v24, v98, v99
    v_max3_f32 v24, v24, v100, v101
    v_max3_f32 v24, v24, v102, v103
    v_mfma_f32_16x16x32_bf16 v[32:35], a[160:163], v[16:19], 0
    v_mfma_f32_16x16x32_bf16 v[36:39], a[160:163], v[20:23], 0
    v_mfma_f32_16x16x32_bf16 v[40:43], a[164:167], v[16:19], 0
    v_mfma_f32_16x16x32_bf16 v[44:47], a[164:167], v[20:23], 0
    v_mfma_f32_16x16x32_bf16 v[48:51], a[168:171], v[16:19], 0
    v_mfma_f32_16x16x32_bf16 v[52:55], a[168:171], v[20:23], 0
    v_mfma_f32_16x16x32_bf16 v[56:59], a[172:175], v[16:19], 0
    v_mfma_f32_16x16x32_bf16 v[60:63], a[172:175], v[20:23], 0
    s_nop 1
    v_add_f32 v33, v33, v39
    v_add_f32 v32, v32, v38
    v_add_f32 v41, v41, v47
    v_add_f32 v40, v40, v46
    v_add_f32 v49, v49, v55
    v_add_f32 v48, v48, v54
    v_add_f32 v57, v57, v63
    v_add_f32 v56, v56, v62
    v_add_f32_dpp v104, v33, v32 row_ror:8 row_mask:0xf bank_mask:0xf
    v_add_f32_dpp v105, v41, v40 row_ror:8 row_mask:0xf bank_mask:0xf
    v_add_f32_dpp v106, v49, v48 row_ror:8 row_mask:0xf bank_mask:0xf
    v_add_f32_dpp v107, v57, v56 row_ror:8 row_mask:0xf bank_mask:0xf
    s_waitcnt vmcnt(6)
    buffer_load_dwordx4 a[220:223], v3, s[28:31], s73 offen offset:3072 nt
    v_mfma_f32_16x16x32_bf16 v[32:35], a[176:179], v[16:19], 0
    v_mfma_f32_16x16x32_bf16 v[36:39], a[176:179], v[20:23], 0
    v_mfma_f32_16x16x32_bf16 v[40:43], a[180:183], v[16:19], 0
    v_mfma_f32_16x16x32_bf16 v[44:47], a[180:183], v[20:23], 0
    v_mfma_f32_16x16x32_bf16 v[48:51], a[184:187], v[16:19], 0
    v_mfma_f32_16x16x32_bf16 v[52:55], a[184:187], v[20:23], 0
    v_mfma_f32_16x16x32_bf16 v[56:59], a[188:191], v[16:19], 0
    v_mfma_f32_16x16x32_bf16 v[60:63], a[188:191], v[20:23], 0
    s_nop 1
    v_add_f32 v33, v33, v39
    v_add_f32 v32, v32, v38
    v_add_f32 v41, v41, v47
    v_add_f32 v40, v40, v46
    v_add_f32 v49, v49, v55
    v_add_f32 v48, v48, v54
    v_add_f32 v57, v57, v63
    v_add_f32 v56, v56, v62
    v_add_f32_dpp v108, v33, v32 row_ror:8 row_mask:0xf bank_mask:0xf
    v_add_f32_dpp v109, v41, v40 row_ror:8 row_mask:0xf bank_mask:0xf
    v_add_f32_dpp v110, v49, v48 row_ror:8 row_mask:0xf bank_mask:0xf
    v_add_f32_dpp v111, v57, v56 row_ror:8 row_mask:0xf bank_mask:0xf
    s_add_u32 s73, s72, 12648448
    s_waitcnt vmcnt(6)
    buffer_load_dwordx4 a[224:227], v3, s[28:31], s73 offen nt
    v_cvt_pk_bf16_f32 v48, v104, v105
    v_cvt_pk_bf16_f32 v49, v106, v107
    v_cvt_pk_bf16_f32 v50, v108, v109
    v_cvt_pk_bf16_f32 v51, v110, v111
    v_lshlrev_b32 v104, 16, v48
    v_and_b32 v105, s86, v48
    v_lshlrev_b32 v106, 16, v49
    v_and_b32 v107, s86, v49
    v_lshlrev_b32 v108, 16, v50
    v_and_b32 v109, s86, v50
    v_lshlrev_b32 v110, 16, v51
    v_and_b32 v111, s86, v51
    v_mul_f32 v104, 0x3db504f3, v104
    v_mul_f32 v105, 0x3db504f3, v105
    v_mul_f32 v106, 0x3db504f3, v106
    v_mul_f32 v107, 0x3db504f3, v107
    v_mul_f32 v108, 0x3db504f3, v108
    v_mul_f32 v109, 0x3db504f3, v109
    v_mul_f32 v110, 0x3db504f3, v110
    v_mul_f32 v111, 0x3db504f3, v111
    v_cvt_pk_bf16_f32 v48, v104, v105
    v_cvt_pk_bf16_f32 v49, v106, v107
    v_cvt_pk_bf16_f32 v50, v108, v109
    v_cvt_pk_bf16_f32 v51, v110, v111
    v_lshlrev_b32 v104, 16, v48
    v_and_b32 v105, s86, v48
    v_lshlrev_b32 v106, 16, v49
    v_and_b32 v107, s86, v49
    v_lshlrev_b32 v108, 16, v50
    v_and_b32 v109, s86, v50
    v_lshlrev_b32 v110, 16, v51
    v_and_b32 v111, s86, v51
    v_max3_f32 v24, v24, v104, v105
    v_max3_f32 v24, v24, v106, v107
    v_max3_f32 v24, v24, v108, v109
    v_max3_f32 v24, v24, v110, v111
    s_waitcnt vmcnt(6)
    buffer_load_dwordx4 a[228:231], v3, s[28:31], s73 offen offset:1024 nt
    s_waitcnt vmcnt(6)
    buffer_load_dwordx4 a[232:235], v3, s[28:31], s73 offen offset:2048 nt
    s_waitcnt vmcnt(6)
    buffer_load_dwordx4 a[236:239], v3, s[28:31], s73 offen offset:3072 nt
    s_add_u32 s73, s72, 13172736
    s_waitcnt vmcnt(6)
    buffer_load_dwordx4 a[240:243], v3, s[28:31], s73 offen nt
    s_waitcnt vmcnt(6)
    buffer_load_dwordx4 a[244:247], v3, s[28:31], s73 offen offset:1024 nt
    s_waitcnt vmcnt(6)
    v_mfma_f32_16x16x32_bf16 v[32:35], a[192:195], v[16:19], 0
    v_mfma_f32_16x16x32_bf16 v[36:39], a[192:195], v[20:23], 0
    v_mfma_f32_16x16x32_bf16 v[40:43], a[196:199], v[16:19], 0
    v_mfma_f32_16x16x32_bf16 v[44:47], a[196:199], v[20:23], 0
    v_mfma_f32_16x16x32_bf16 v[48:51], a[200:203], v[16:19], 0
    v_mfma_f32_16x16x32_bf16 v[52:55], a[200:203], v[20:23], 0
    v_mfma_f32_16x16x32_bf16 v[56:59], a[204:207], v[16:19], 0
    v_mfma_f32_16x16x32_bf16 v[60:63], a[204:207], v[20:23], 0
    s_nop 1
    v_add_f32 v33, v33, v39
    v_add_f32 v32, v32, v38
    v_add_f32 v41, v41, v47
    v_add_f32 v40, v40, v46
    v_add_f32 v49, v49, v55
    v_add_f32 v48, v48, v54
    v_add_f32 v57, v57, v63
    v_add_f32 v56, v56, v62
    v_add_f32_dpp v112, v33, v32 row_ror:8 row_mask:0xf bank_mask:0xf
    v_add_f32_dpp v113, v41, v40 row_ror:8 row_mask:0xf bank_mask:0xf
    v_add_f32_dpp v114, v49, v48 row_ror:8 row_mask:0xf bank_mask:0xf
    v_add_f32_dpp v115, v57, v56 row_ror:8 row_mask:0xf bank_mask:0xf
    buffer_load_dwordx4 a[248:251], v3, s[28:31], s73 offen offset:2048 nt
    v_mfma_f32_16x16x32_bf16 v[32:35], a[208:211], v[16:19], 0
    v_mfma_f32_16x16x32_bf16 v[36:39], a[208:211], v[20:23], 0
    v_mfma_f32_16x16x32_bf16 v[40:43], a[212:215], v[16:19], 0
    v_mfma_f32_16x16x32_bf16 v[44:47], a[212:215], v[20:23], 0
    v_mfma_f32_16x16x32_bf16 v[48:51], a[216:219], v[16:19], 0
    v_mfma_f32_16x16x32_bf16 v[52:55], a[216:219], v[20:23], 0
    v_mfma_f32_16x16x32_bf16 v[56:59], a[220:223], v[16:19], 0
    v_mfma_f32_16x16x32_bf16 v[60:63], a[220:223], v[20:23], 0
    s_nop 1
    v_add_f32 v33, v33, v39
    v_add_f32 v32, v32, v38
    v_add_f32 v41, v41, v47
    v_add_f32 v40, v40, v46
    v_add_f32 v49, v49, v55
    v_add_f32 v48, v48, v54
    v_add_f32 v57, v57, v63
    v_add_f32 v56, v56, v62
    v_add_f32_dpp v116, v33, v32 row_ror:8 row_mask:0xf bank_mask:0xf
    v_add_f32_dpp v117, v41, v40 row_ror:8 row_mask:0xf bank_mask:0xf
    v_add_f32_dpp v118, v49, v48 row_ror:8 row_mask:0xf bank_mask:0xf
    v_add_f32_dpp v119, v57, v56 row_ror:8 row_mask:0xf bank_mask:0xf
    s_waitcnt vmcnt(6)
    buffer_load_dwordx4 a[252:255], v3, s[28:31], s73 offen offset:3072 nt
    v_cvt_pk_bf16_f32 v48, v112, v113
    v_cvt_pk_bf16_f32 v49, v114, v115
    v_cvt_pk_bf16_f32 v50, v116, v117
    v_cvt_pk_bf16_f32 v51, v118, v119
    v_lshlrev_b32 v112, 16, v48
    v_and_b32 v113, s86, v48
    v_lshlrev_b32 v114, 16, v49
    v_and_b32 v115, s86, v49
    v_lshlrev_b32 v116, 16, v50
    v_and_b32 v117, s86, v50
    v_lshlrev_b32 v118, 16, v51
    v_and_b32 v119, s86, v51
    v_mul_f32 v112, 0x3db504f3, v112
    v_mul_f32 v113, 0x3db504f3, v113
    v_mul_f32 v114, 0x3db504f3, v114
    v_mul_f32 v115, 0x3db504f3, v115
    v_mul_f32 v116, 0x3db504f3, v116
    v_mul_f32 v117, 0x3db504f3, v117
    v_mul_f32 v118, 0x3db504f3, v118
    v_mul_f32 v119, 0x3db504f3, v119
    v_cvt_pk_bf16_f32 v48, v112, v113
    v_cvt_pk_bf16_f32 v49, v114, v115
    v_cvt_pk_bf16_f32 v50, v116, v117
    v_cvt_pk_bf16_f32 v51, v118, v119
    v_lshlrev_b32 v112, 16, v48
    v_and_b32 v113, s86, v48
    v_lshlrev_b32 v114, 16, v49
    v_and_b32 v115, s86, v49
    v_lshlrev_b32 v116, 16, v50
    v_and_b32 v117, s86, v50
    v_lshlrev_b32 v118, 16, v51
    v_and_b32 v119, s86, v51
    v_max3_f32 v24, v24, v112, v113
    v_max3_f32 v24, v24, v114, v115
    v_max3_f32 v24, v24, v116, v117
    v_max3_f32 v24, v24, v118, v119
    s_add_u32 s73, s72, 0
    s_waitcnt vmcnt(5)
    buffer_load_dwordx4 v[128:131], v2, s[32:35], s73 offen nt
    s_waitcnt vmcnt(5)
    buffer_load_dwordx4 v[132:135], v2, s[32:35], s73 offen offset:1024 nt
    s_waitcnt vmcnt(5)
    buffer_load_dwordx4 v[136:139], v2, s[32:35], s73 offen offset:2048 nt
    s_waitcnt vmcnt(5)
    buffer_load_dwordx4 v[140:143], v2, s[32:35], s73 offen offset:3072 nt
    s_add_u32 s73, s72, 524288
    s_waitcnt vmcnt(5)
    buffer_load_dwordx4 v[144:147], v2, s[32:35], s73 offen nt
    s_waitcnt vmcnt(5)
    buffer_load_dwordx4 v[148:151], v2, s[32:35], s73 offen offset:1024 nt
    v_mfma_f32_16x16x32_bf16 v[32:35], a[224:227], v[16:19], 0
    v_mfma_f32_16x16x32_bf16 v[36:39], a[224:227], v[20:23], 0
    v_mfma_f32_16x16x32_bf16 v[40:43], a[228:231], v[16:19], 0
    v_mfma_f32_16x16x32_bf16 v[44:47], a[228:231], v[20:23], 0
    v_mfma_f32_16x16x32_bf16 v[48:51], a[232:235], v[16:19], 0
    v_mfma_f32_16x16x32_bf16 v[52:55], a[232:235], v[20:23], 0
    v_mfma_f32_16x16x32_bf16 v[56:59], a[236:239], v[16:19], 0
    v_mfma_f32_16x16x32_bf16 v[60:63], a[236:239], v[20:23], 0
    s_nop 1
    v_add_f32 v33, v33, v39
    v_add_f32 v32, v32, v38
    v_add_f32 v41, v41, v47
    v_add_f32 v40, v40, v46
    v_add_f32 v49, v49, v55
    v_add_f32 v48, v48, v54
    v_add_f32 v57, v57, v63
    v_add_f32 v56, v56, v62
    v_add_f32_dpp v120, v33, v32 row_ror:8 row_mask:0xf bank_mask:0xf
    v_add_f32_dpp v121, v41, v40 row_ror:8 row_mask:0xf bank_mask:0xf
    v_add_f32_dpp v122, v49, v48 row_ror:8 row_mask:0xf bank_mask:0xf
    v_add_f32_dpp v123, v57, v56 row_ror:8 row_mask:0xf bank_mask:0xf
    s_waitcnt vmcnt(5)
    buffer_load_dwordx4 v[152:155], v2, s[32:35], s73 offen offset:2048 nt
    v_mfma_f32_16x16x32_bf16 v[32:35], a[240:243], v[16:19], 0
    v_mfma_f32_16x16x32_bf16 v[36:39], a[240:243], v[20:23], 0
    v_mfma_f32_16x16x32_bf16 v[40:43], a[244:247], v[16:19], 0
    v_mfma_f32_16x16x32_bf16 v[44:47], a[244:247], v[20:23], 0
    v_mfma_f32_16x16x32_bf16 v[48:51], a[248:251], v[16:19], 0
    v_mfma_f32_16x16x32_bf16 v[52:55], a[248:251], v[20:23], 0
    v_mfma_f32_16x16x32_bf16 v[56:59], a[252:255], v[16:19], 0
    v_mfma_f32_16x16x32_bf16 v[60:63], a[252:255], v[20:23], 0
    s_nop 1
    v_add_f32 v33, v33, v39
    v_add_f32 v32, v32, v38
    v_add_f32 v41, v41, v47
    v_add_f32 v40, v40, v46
    v_add_f32 v49, v49, v55
    v_add_f32 v48, v48, v54
    v_add_f32 v57, v57, v63
    v_add_f32 v56, v56, v62
    v_add_f32_dpp v124, v33, v32 row_ror:8 row_mask:0xf bank_mask:0xf
    v_add_f32_dpp v125, v41, v40 row_ror:8 row_mask:0xf bank_mask:0xf
    v_add_f32_dpp v126, v49, v48 row_ror:8 row_mask:0xf bank_mask:0xf
    v_add_f32_dpp v127, v57, v56 row_ror:8 row_mask:0xf bank_mask:0xf
    s_waitcnt vmcnt(5)
    buffer_load_dwordx4 v[156:159], v2, s[32:35], s73 offen offset:3072 nt
    v_cvt_pk_bf16_f32 v48, v120, v121
    v_cvt_pk_bf16_f32 v49, v122, v123
    v_cvt_pk_bf16_f32 v50, v124, v125
    v_cvt_pk_bf16_f32 v51, v126, v127
    v_lshlrev_b32 v120, 16, v48
    v_and_b32 v121, s86, v48
    v_lshlrev_b32 v122, 16, v49
    v_and_b32 v123, s86, v49
    v_lshlrev_b32 v124, 16, v50
    v_and_b32 v125, s86, v50
    v_lshlrev_b32 v126, 16, v51
    v_and_b32 v127, s86, v51
    v_mul_f32 v120, 0x3db504f3, v120
    v_mul_f32 v121, 0x3db504f3, v121
    v_mul_f32 v122, 0x3db504f3, v122
    v_mul_f32 v123, 0x3db504f3, v123
    v_mul_f32 v124, 0x3db504f3, v124
    v_mul_f32 v125, 0x3db504f3, v125
    v_mul_f32 v126, 0x3db504f3, v126
    v_mul_f32 v127, 0x3db504f3, v127
    v_cvt_pk_bf16_f32 v48, v120, v121
    v_cvt_pk_bf16_f32 v49, v122, v123
    v_cvt_pk_bf16_f32 v50, v124, v125
    v_cvt_pk_bf16_f32 v51, v126, v127
    v_lshlrev_b32 v120, 16, v48
    v_and_b32 v121, s86, v48
    v_lshlrev_b32 v122, 16, v49
    v_and_b32 v123, s86, v49
    v_lshlrev_b32 v124, 16, v50
    v_and_b32 v125, s86, v50
    v_lshlrev_b32 v126, 16, v51
    v_and_b32 v127, s86, v51
    v_max3_f32 v24, v24, v120, v121
    v_max3_f32 v24, v24, v122, v123
    v_max3_f32 v24, v24, v124, v125
    v_max3_f32 v24, v24, v126, v127
    v_mov_b32 v27, v24
    s_nop 1
    v_permlane16_swap_b32 v24, v27
    v_max_f32 v24, v24, v27
    v_mov_b32 v27, v24
    s_nop 1
    v_permlane32_swap_b32 v24, v27
    v_max_f32 v24, v24, v27
    v_mul_f32 v29, s91, v24
    v_mov_b32 v25, 0
    v_fma_f32 v64, v64, s91, -v29
    v_fma_f32 v65, v65, s91, -v29
    v_fma_f32 v66, v66, s91, -v29
    v_fma_f32 v67, v67, s91, -v29
    v_fma_f32 v68, v68, s91, -v29
    v_fma_f32 v69, v69, s91, -v29
    v_fma_f32 v70, v70, s91, -v29
    v_fma_f32 v71, v71, s91, -v29
    v_exp_f32 v64, v64
    v_exp_f32 v65, v65
    v_exp_f32 v66, v66
    v_exp_f32 v67, v67
    v_exp_f32 v68, v68
    v_exp_f32 v69, v69
    v_exp_f32 v70, v70
    v_exp_f32 v71, v71
    v_add_f32 v27, v64, v65
    v_add_f32 v28, v66, v67
    v_add_f32 v27, v27, v68
    v_add_f32 v28, v28, v69
    v_add_f32 v27, v27, v70
    v_add_f32 v28, v28, v71
    v_add_f32 v25, v25, v27
    v_add_f32 v25, v25, v28
    v_cvt_pk_bf16_f32 v64, v64, v65
    v_cvt_pk_bf16_f32 v65, v66, v67
    v_cvt_pk_bf16_f32 v66, v68, v69
    v_cvt_pk_bf16_f32 v67, v70, v71
    v_fma_f32 v72, v72, s91, -v29
    v_fma_f32 v73, v73, s91, -v29
    v_fma_f32 v74, v74, s91, -v29
    v_fma_f32 v75, v75, s91, -v29
    v_fma_f32 v76, v76, s91, -v29
    v_fma_f32 v77, v77, s91, -v29
    v_fma_f32 v78, v78, s91, -v29
    v_fma_f32 v79, v79, s91, -v29
    v_exp_f32 v72, v72
    v_exp_f32 v73, v73
    v_exp_f32 v74, v74
    v_exp_f32 v75, v75
    v_exp_f32 v76, v76
    v_exp_f32 v77, v77
    v_exp_f32 v78, v78
    v_exp_f32 v79, v79
    v_add_f32 v27, v72, v73
    v_add_f32 v28, v74, v75
    v_add_f32 v27, v27, v76
    v_add_f32 v28, v28, v77
    v_add_f32 v27, v27, v78
    v_add_f32 v28, v28, v79
    v_add_f32 v25, v25, v27
    v_add_f32 v25, v25, v28
    v_cvt_pk_bf16_f32 v72, v72, v73
    v_cvt_pk_bf16_f32 v73, v74, v75
    v_cvt_pk_bf16_f32 v74, v76, v77
    v_cvt_pk_bf16_f32 v75, v78, v79
    s_add_u32 s73, s72, 65536
    s_waitcnt vmcnt(5)
    buffer_load_dwordx4 v[160:163], v2, s[32:35], s73 offen nt
    s_mov_b32 s68, s24
    s_mov_b32 s69, s25
    s_mov_b32 s70, 256
    s_mov_b32 s71, 0x20000
    s_cmp_lg_u32 s3, 0
    s_cbranch_scc1 L_skip_6
    v_mov_b32 v4, 1
    s_lshl_b32 s76, s74, 6
    s_mov_b64 exec, 1
    buffer_atomic_add v4, v1, s[68:71], s76 offen sc0
    s_mov_b64 exec, -1
L_skip_6:
    v_fma_f32 v80, v80, s91, -v29
    v_fma_f32 v81, v81, s91, -v29
    v_fma_f32 v82, v82, s91, -v29
    v_fma_f32 v83, v83, s91, -v29
    v_fma_f32 v84, v84, s91, -v29
    v_fma_f32 v85, v85, s91, -v29
    v_fma_f32 v86, v86, s91, -v29
    v_fma_f32 v87, v87, s91, -v29
    v_exp_f32 v80, v80
    v_exp_f32 v81, v81
    v_exp_f32 v82, v82
    v_exp_f32 v83, v83
    v_exp_f32 v84, v84
    v_exp_f32 v85, v85
    v_exp_f32 v86, v86
    v_exp_f32 v87, v87
    v_add_f32 v27, v80, v81
    v_add_f32 v28, v82, v83
    v_add_f32 v27, v27, v84
    v_add_f32 v28, v28, v85
    v_add_f32 v27, v27, v86
    v_add_f32 v28, v28, v87
    v_add_f32 v25, v25, v27
    v_add_f32 v25, v25, v28
    v_cvt_pk_bf16_f32 v80, v80, v81
    v_cvt_pk_bf16_f32 v81, v82, v83
    v_cvt_pk_bf16_f32 v82, v84, v85
    v_cvt_pk_bf16_f32 v83, v86, v87
    s_waitcnt vmcnt(5)
    buffer_load_dwordx4 v[164:167], v2, s[32:35], s73 offen offset:1024 nt
    v_fma_f32 v88, v88, s91, -v29
    v_fma_f32 v89, v89, s91, -v29
    v_fma_f32 v90, v90, s91, -v29
    v_fma_f32 v91, v91, s91, -v29
    v_fma_f32 v92, v92, s91, -v29
    v_fma_f32 v93, v93, s91, -v29
    v_fma_f32 v94, v94, s91, -v29
    v_fma_f32 v95, v95, s91, -v29
    v_exp_f32 v88, v88
    v_exp_f32 v89, v89
    v_exp_f32 v90, v90
    v_exp_f32 v91, v91
    v_exp_f32 v92, v92
    v_exp_f32 v93, v93
    v_exp_f32 v94, v94
    v_exp_f32 v95, v95
    v_add_f32 v27, v88, v89
    v_add_f32 v28, v90, v91
    v_add_f32 v27, v27, v92
    v_add_f32 v28, v28, v93
    v_add_f32 v27, v27, v94
    v_add_f32 v28, v28, v95
    v_add_f32 v25, v25, v27
    v_add_f32 v25, v25, v28
    v_cvt_pk_bf16_f32 v88, v88, v89
    v_cvt_pk_bf16_f32 v89, v90, v91
    v_cvt_pk_bf16_f32 v90, v92, v93
    v_cvt_pk_bf16_f32 v91, v94, v95
    s_waitcnt vmcnt(5)
    buffer_load_dwordx4 v[168:171], v2, s[32:35], s73 offen offset:2048 nt
    v_fma_f32 v96, v96, s91, -v29
    v_fma_f32 v97, v97, s91, -v29
    v_fma_f32 v98, v98, s91, -v29
    v_fma_f32 v99, v99, s91, -v29
    v_fma_f32 v100, v100, s91, -v29
    v_fma_f32 v101, v101, s91, -v29
    v_fma_f32 v102, v102, s91, -v29
    v_fma_f32 v103, v103, s91, -v29
    v_exp_f32 v96, v96
    v_exp_f32 v97, v97
    v_exp_f32 v98, v98
    v_exp_f32 v99, v99
    v_exp_f32 v100, v100
    v_exp_f32 v101, v101
    v_exp_f32 v102, v102
    v_exp_f32 v103, v103
    v_add_f32 v27, v96, v97
    v_add_f32 v28, v98, v99
    v_add_f32 v27, v27, v100
    v_add_f32 v28, v28, v101
    v_add_f32 v27, v27, v102
    v_add_f32 v28, v28, v103
    v_add_f32 v25, v25, v27
    v_add_f32 v25, v25, v28
    v_cvt_pk_bf16_f32 v96, v96, v97
    v_cvt_pk_bf16_f32 v97, v98, v99
    v_cvt_pk_bf16_f32 v98, v100, v101
    v_cvt_pk_bf16_f32 v99, v102, v103
    s_waitcnt vmcnt(5)
    buffer_load_dwordx4 v[172:175], v2, s[32:35], s73 offen offset:3072 nt
    v_fma_f32 v104, v104, s91, -v29
    v_fma_f32 v105, v105, s91, -v29
    v_fma_f32 v106, v106, s91, -v29
    v_fma_f32 v107, v107, s91, -v29
    v_fma_f32 v108, v108, s91, -v29
    v_fma_f32 v109, v109, s91, -v29
    v_fma_f32 v110, v110, s91, -v29
    v_fma_f32 v111, v111, s91, -v29
    v_exp_f32 v104, v104
    v_exp_f32 v105, v105
    v_exp_f32 v106, v106
    v_exp_f32 v107, v107
    v_exp_f32 v108, v108
    v_exp_f32 v109, v109
    v_exp_f32 v110, v110
    v_exp_f32 v111, v111
    v_add_f32 v27, v104, v105
    v_add_f32 v28, v106, v107
    v_add_f32 v27, v27, v108
    v_add_f32 v28, v28, v109
    v_add_f32 v27, v27, v110
    v_add_f32 v28, v28, v111
    v_add_f32 v25, v25, v27
    v_add_f32 v25, v25, v28
    v_cvt_pk_bf16_f32 v104, v104, v105
    v_cvt_pk_bf16_f32 v105, v106, v107
    v_cvt_pk_bf16_f32 v106, v108, v109
    v_cvt_pk_bf16_f32 v107, v110, v111
    s_add_u32 s73, s72, 589824
    s_waitcnt vmcnt(5)
    buffer_load_dwordx4 v[176:179], v2, s[32:35], s73 offen nt
    v_fma_f32 v112, v112, s91, -v29
    v_fma_f32 v113, v113, s91, -v29
    v_fma_f32 v114, v114, s91, -v29
    v_fma_f32 v115, v115, s91, -v29
    v_fma_f32 v116, v116, s91, -v29
    v_fma_f32 v117, v117, s91, -v29
    v_fma_f32 v118, v118, s91, -v29
    v_fma_f32 v119, v119, s91, -v29
    v_exp_f32 v112, v112
    v_exp_f32 v113, v113
    v_exp_f32 v114, v114
    v_exp_f32 v115, v115
    v_exp_f32 v116, v116
    v_exp_f32 v117, v117
    v_exp_f32 v118, v118
    v_exp_f32 v119, v119
    v_add_f32 v27, v112, v113
    v_add_f32 v28, v114, v115
    v_add_f32 v27, v27, v116
    v_add_f32 v28, v28, v117
    v_add_f32 v27, v27, v118
    v_add_f32 v28, v28, v119
    v_add_f32 v25, v25, v27
    v_add_f32 v25, v25, v28
    v_cvt_pk_bf16_f32 v112, v112, v113
    v_cvt_pk_bf16_f32 v113, v114, v115
    v_cvt_pk_bf16_f32 v114, v116, v117
    v_cvt_pk_bf16_f32 v115, v118, v119
    s_waitcnt vmcnt(5)
    buffer_load_dwordx4 v[180:183], v2, s[32:35], s73 offen offset:1024 nt
    v_fma_f32 v120, v120, s91, -v29
    v_fma_f32 v121, v121, s91, -v29
    v_fma_f32 v122, v122, s91, -v29
    v_fma_f32 v123, v123, s91, -v29
    v_fma_f32 v124, v124, s91, -v29
    v_fma_f32 v125, v125, s91, -v29
    v_fma_f32 v126, v126, s91, -v29
    v_fma_f32 v127, v127, s91, -v29
    v_exp_f32 v120, v120
    v_exp_f32 v121, v121
    v_exp_f32 v122, v122
    v_exp_f32 v123, v123
    v_exp_f32 v124, v124
    v_exp_f32 v125, v125
    v_exp_f32 v126, v126
    v_exp_f32 v127, v127
    v_add_f32 v27, v120, v121
    v_add_f32 v28, v122, v123
    v_add_f32 v27, v27, v124
    v_add_f32 v28, v28, v125
    v_add_f32 v27, v27, v126
    v_add_f32 v28, v28, v127
    v_add_f32 v25, v25, v27
    v_add_f32 v25, v25, v28
    v_cvt_pk_bf16_f32 v120, v120, v121
    v_cvt_pk_bf16_f32 v121, v122, v123
    v_cvt_pk_bf16_f32 v122, v124, v125
    v_cvt_pk_bf16_f32 v123, v126, v127
    v_mov_b32 v27, v25
    s_nop 1
    v_permlane16_swap_b32 v25, v27
    v_add_f32 v25, v25, v27
    v_mov_b32 v27, v25
    s_nop 1
    v_permlane32_swap_b32 v25, v27
    v_add_f32 v25, v25, v27
    s_lshl_b32 s76, s3, 2
    s_add_u32 s76, s76, 5120
    v_lshl_add_u32 v27, v30, 4, s76
    ds_write_b32 v27, v24
    ds_write_b32 v27, v25 offset:256
    s_cmp_lg_u32 s3, 0
    s_cbranch_scc1 L_skip_7
    s_waitcnt vmcnt(5)
    s_mov_b64 exec, 1
    ds_write_b32 v1, v4 offset:7680
    s_mov_b64 exec, -1
L_skip_7:
    s_waitcnt lgkmcnt(0)
    s_barrier
    v_mov_b32 v28, 0
    ds_read_b32 v4, v28 offset:7680
    s_cmp_lg_u32 s3, 0
    s_cbranch_scc1 L_skip_8
    v_lshlrev_b32 v27, 4, v30
    ds_read_b128 v[32:35], v27 offset:5120
    ds_read_b128 v[36:39], v27 offset:5376
    s_lshl_b32 s76, s74, 14
    s_lshr_b32 s77, s75, 2
    s_lshl_b32 s77, s77, 10
    s_add_u32 s76, s76, s77
    s_and_b32 s77, s75, 3
    s_lshl_b32 s77, s77, 7
    s_add_u32 s76, s76, s77
    s_add_u32 s76, s76, 393728
    v_lshlrev_b32 v27, 3, v1
    s_waitcnt lgkmcnt(0)
    v_max3_f32 v40, v32, v33, v34
    v_max_f32 v40, v40, v35
    v_and_b32 v40, s6, v40
    v_sub_f32 v32, v32, v40
    v_sub_f32 v33, v33, v40
    v_sub_f32 v34, v34, v40
    v_sub_f32 v35, v35, v40
    v_mul_f32 v32, s91, v32
    v_mul_f32 v33, s91, v33
    v_mul_f32 v34, s91, v34
    v_mul_f32 v35, s91, v35
    v_exp_f32 v32, v32
    v_exp_f32 v33, v33
    v_exp_f32 v34, v34
    v_exp_f32 v35, v35
    v_mul_f32 v41, v32, v36
    v_fmac_f32 v41, v33, v37
    v_fmac_f32 v41, v34, v38
    v_fmac_f32 v41, v35, v39
    v_and_or_b32 v40, v40, s6, v5
    v_add_u32 v41, 0x80, v41
    v_and_or_b32 v41, v41, s6, v5
    s_mov_b64 exec, 0xff
    buffer_store_dwordx2 v[40:41], v27, s[56:59], s76 offen sc1
    s_mov_b64 exec, -1
L_skip_8:
    s_waitcnt lgkmcnt(0)
    v_readfirstlane_b32 s76, v4
    s_nop 0
    s_and_b32 s76, s76, 63
    s_mov_b32 s21, 0
    s_cmp_lt_u32 s76, 56
    s_addc_u32 s21, s21, 0
    s_cmp_lt_u32 s76, 8
    s_addc_u32 s21, s21, 0
    s_lshl_b32 s77, s74, 6
    s_or_b32 s76, s76, s77
    s_lshr_b32 s8, s76, 3
    s_and_b32 s7, s76, 7
    s_lshl_b32 s9, s8, 2
    s_add_u32 s9, s9, s3
    s_mul_i32 s80, s9, 57344
    s_lshl_b32 s77, s7, 8
    s_add_u32 s80, s80, s77
    s_xor_b32 s76, s76, 63
    s_lshr_b32 s23, s76, 3
    s_and_b32 s22, s76, 7
    s_lshl_b32 s26, s23, 2
    s_add_u32 s26, s26, s3
    s_mul_i32 s27, s26, 57344
    s_lshl_b32 s77, s22, 8
    s_add_u32 s27, s27, s77
    s_waitcnt vmcnt(5)
    buffer_load_dwordx4 v[184:187], v2, s[32:35], s73 offen offset:2048 nt
    v_and_b32 v27, 7, v1
    v_min_u32 v27, 6, v27
    s_mul_i32 s76, s9, 112
    v_lshl_add_u32 v27, v27, 4, s76
    v_and_b32 v28, 0xfffffe00, v27
    v_add_u32 v27, v27, v28
    v_bfe_u32 v28, v1, 3, 2
    v_mul_u32_u24 v28, 28672, v28
    v_add_u32 v27, v27, v28
    v_lshrrev_b32 v28, 5, v1
    v_lshl_add_u32 v116, v28, 17, v27
    s_mov_b32 s14, 131584
    buffer_load_dwordx4 v[100:103], v116, s[56:59], s14 offen sc1
    s_waitcnt vmcnt(6)
    buffer_load_dwordx4 v[188:191], v2, s[32:35], s73 offen offset:3072 nt
    s_xor_b32 s93, s21, 2
    s_cmp_lg_u32 s93, 0
    s_cbranch_scc1 L_skip_9
    v_and_b32 v27, 7, v1
    v_min_u32 v27, 6, v27
    s_mul_i32 s76, s26, 112
    v_lshl_add_u32 v27, v27, 4, s76
    v_and_b32 v28, 0xfffffe00, v27
    v_add_u32 v27, v27, v28
    v_bfe_u32 v28, v1, 3, 2
    v_mul_u32_u24 v28, 28672, v28
    v_add_u32 v27, v27, v28
    v_lshrrev_b32 v28, 5, v1
    v_lshl_add_u32 v117, v28, 17, v27
    s_mov_b32 s14, 131584
    buffer_load_dwordx4 v[108:111], v117, s[56:59], s14 offen sc1
L_skip_9:
    v_perm_b32 v32, v132, v128, s82
    v_perm_b32 v33, v140, v136, s82
    v_perm_b32 v34, v148, v144, s82
    v_perm_b32 v35, v156, v152, s82
    v_perm_b32 v36, v132, v128, s83
    v_perm_b32 v37, v140, v136, s83
    v_perm_b32 v38, v148, v144, s83
    v_perm_b32 v39, v156, v152, s83
    v_mfma_f32_16x16x32_bf16 a[0:3], v[64:67], v[32:35], 0
    v_perm_b32 v40, v133, v129, s82
    v_perm_b32 v41, v141, v137, s82
    v_perm_b32 v42, v149, v145, s82
    v_perm_b32 v43, v157, v153, s82
    v_mfma_f32_16x16x32_bf16 a[4:7], v[64:67], v[36:39], 0
    v_perm_b32 v44, v133, v129, s83
    v_perm_b32 v45, v141, v137, s83
    v_perm_b32 v46, v149, v145, s83
    v_perm_b32 v47, v157, v153, s83
    v_mfma_f32_16x16x32_bf16 a[8:11], v[64:67], v[40:43], 0
    v_perm_b32 v48, v134, v130, s82
    v_perm_b32 v49, v142, v138, s82
    v_perm_b32 v50, v150, v146, s82
    v_perm_b32 v51, v158, v154, s82
    v_mfma_f32_16x16x32_bf16 a[12:15], v[64:67], v[44:47], 0
    s_add_u32 s73, s72, 4194304
    s_waitcnt vmcnt(6)
    buffer_load_dwordx4 v[192:195], v2, s[32:35], s73 offen nt
    v_perm_b32 v52, v134, v130, s83
    v_perm_b32 v53, v142, v138, s83
    v_perm_b32 v54, v150, v146, s83
    v_perm_b32 v55, v158, v154, s83
    v_mfma_f32_16x16x32_bf16 a[16:19], v[64:67], v[48:51], 0
    v_perm_b32 v56, v135, v131, s82
    v_perm_b32 v57, v143, v139, s82
    v_perm_b32 v58, v151, v147, s82
    v_perm_b32 v59, v159, v155, s82
    v_mfma_f32_16x16x32_bf16 a[20:23], v[64:67], v[52:55], 0
    v_perm_b32 v60, v135, v131, s83
    v_perm_b32 v61, v143, v139, s83
    v_perm_b32 v62, v151, v147, s83
    v_perm_b32 v63, v159, v155, s83
    v_mfma_f32_16x16x32_bf16 a[24:27], v[64:67], v[56:59], 0
    s_nop 0
    v_mfma_f32_16x16x32_bf16 a[28:31], v[64:67], v[60:63], 0
    s_waitcnt vmcnt(6)
    buffer_load_dwordx4 v[196:199], v2, s[32:35], s73 offen offset:1024 nt
    s_waitcnt vmcnt(6)
    buffer_load_dwordx4 v[200:203], v2, s[32:35], s73 offen offset:2048 nt
    s_waitcnt vmcnt(6)
    buffer_load_dwordx4 v[204:207], v2, s[32:35], s73 offen offset:3072 nt
    s_add_u32 s73, s72, 4718592
    s_waitcnt vmcnt(6)
    buffer_load_dwordx4 v[208:211], v2, s[32:35], s73 offen nt
    s_waitcnt vmcnt(5)
    buffer_load_dwordx4 v[212:215], v2, s[32:35], s73 offen offset:1024 nt
    v_perm_b32 v32, v164, v160, s82
    v_perm_b32 v33, v172, v168, s82
    v_perm_b32 v34, v180, v176, s82
    v_perm_b32 v35, v188, v184, s82
    v_perm_b32 v36, v164, v160, s83
    v_perm_b32 v37, v172, v168, s83
    v_perm_b32 v38, v180, v176, s83
    v_perm_b32 v39, v188, v184, s83
    v_mfma_f32_16x16x32_bf16 a[0:3], v[72:75], v[32:35], a[0:3]
    v_perm_b32 v40, v165, v161, s82
    v_perm_b32 v41, v173, v169, s82
    v_perm_b32 v42, v181, v177, s82
    v_perm_b32 v43, v189, v185, s82
    v_mfma_f32_16x16x32_bf16 a[4:7], v[72:75], v[36:39], a[4:7]
    v_perm_b32 v44, v165, v161, s83
    v_perm_b32 v45, v173, v169, s83
    v_perm_b32 v46, v181, v177, s83
    v_perm_b32 v47, v189, v185, s83
    v_mfma_f32_16x16x32_bf16 a[8:11], v[72:75], v[40:43], a[8:11]
    v_perm_b32 v48, v166, v162, s82
    v_perm_b32 v49, v174, v170, s82
    v_perm_b32 v50, v182, v178, s82
    v_perm_b32 v51, v190, v186, s82
    v_mfma_f32_16x16x32_bf16 a[12:15], v[72:75], v[44:47], a[12:15]
    s_waitcnt vmcnt(5)
    buffer_load_dwordx4 v[216:219], v2, s[32:35], s73 offen offset:2048 nt
    v_perm_b32 v52, v166, v162, s83
    v_perm_b32 v53, v174, v170, s83
    v_perm_b32 v54, v182, v178, s83
    v_perm_b32 v55, v190, v186, s83
    v_mfma_f32_16x16x32_bf16 a[16:19], v[72:75], v[48:51], a[16:19]
    v_perm_b32 v56, v167, v163, s82
    v_perm_b32 v57, v175, v171, s82
    v_perm_b32 v58, v183, v179, s82
    v_perm_b32 v59, v191, v187, s82
    v_mfma_f32_16x16x32_bf16 a[20:23], v[72:75], v[52:55], a[20:23]
    v_perm_b32 v60, v167, v163, s83
    v_perm_b32 v61, v175, v171, s83
    v_perm_b32 v62, v183, v179, s83
    v_perm_b32 v63, v191, v187, s83
    v_mfma_f32_16x16x32_bf16 a[24:27], v[72:75], v[56:59], a[24:27]
    s_nop 0
    v_mfma_f32_16x16x32_bf16 a[28:31], v[72:75], v[60:63], a[28:31]
    s_waitcnt vmcnt(5)
    buffer_load_dwordx4 v[220:223], v2, s[32:35], s73 offen offset:3072 nt
    s_add_u32 s73, s72, 4259840
    s_waitcnt vmcnt(5)
    buffer_load_dwordx4 v[224:227], v2, s[32:35], s73 offen nt
    s_waitcnt vmcnt(5)
    buffer_load_dwordx4 v[228:231], v2, s[32:35], s73 offen offset:1024 nt
    s_waitcnt vmcnt(5)
    buffer_load_dwordx4 v[232:235], v2, s[32:35], s73 offen offset:2048 nt
    s_waitcnt vmcnt(5)
    buffer_load_dwordx4 v[236:239], v2, s[32:35], s73 offen offset:3072 nt
    s_add_u32 s73, s72, 4784128
    s_waitcnt vmcnt(5)
    buffer_load_dwordx4 v[240:243], v2, s[32:35], s73 offen nt
    v_xor_b32 v100, v5, v100
    v_xor_b32 v101, v5, v101
    v_xor_b32 v102, v5, v102
    v_xor_b32 v103, v5, v103
    v_or3_b32 v27, v100, v101, v102
    v_or_b32 v27, v27, v103
    v_and_b32 v27, 0xff, v27
    v_cmp_ne_u32 vcc, 0, v27
    s_cbranch_vccnz L_h_retry_10
L_h_ok_11:
    v_add_f32_dpp v100, v100, v100 row_ror:8 row_mask:0xf bank_mask:0xf
    v_add_f32_dpp v101, v101, v101 row_ror:8 row_mask:0xf bank_mask:0xf
    v_add_f32_dpp v102, v102, v102 row_ror:8 row_mask:0xf bank_mask:0xf
    v_add_f32_dpp v103, v103, v103 row_ror:8 row_mask:0xf bank_mask:0xf
    v_mov_b32 v32, v100
    s_nop 1
    v_permlane16_swap_b32 v100, v32
    v_add_f32 v100, v100, v32
    v_mov_b32 v33, v101
    s_nop 1
    v_permlane16_swap_b32 v101, v33
    v_add_f32 v101, v101, v33
    v_mov_b32 v34, v102
    s_nop 1
    v_permlane16_swap_b32 v102, v34
    v_add_f32 v102, v102, v34
    v_mov_b32 v35, v103
    s_nop 1
    v_permlane16_swap_b32 v103, v35
    v_add_f32 v103, v103, v35
    s_waitcnt vmcnt(5)
    buffer_load_dwordx4 v[244:247], v2, s[32:35], s73 offen offset:1024 nt
    v_cvt_pk_bf16_f32 v100, v100, v100
    v_lshlrev_b32 v100, 16, v100
    v_cvt_pk_bf16_f32 v101, v101, v101
    v_lshlrev_b32 v101, 16, v101
    v_cvt_pk_bf16_f32 v102, v102, v102
    v_lshlrev_b32 v102, 16, v102
    v_cvt_pk_bf16_f32 v103, v103, v103
    v_lshlrev_b32 v103, 16, v103
    v_mov_b32 v32, v100
    v_mov_b32 v33, v101
    v_mov_b32 v34, v102
    v_mov_b32 v35, v103
    v_permlane32_swap_b32 v100, v32
    v_permlane32_swap_b32 v101, v33
    v_permlane32_swap_b32 v102, v34
    v_permlane32_swap_b32 v103, v35
    s_waitcnt vmcnt(5)
    buffer_load_dwordx4 v[248:251], v2, s[32:35], s73 offen offset:2048 nt
    v_mul_f32 v36, s91, v100
    v_mul_f32 v37, s91, v101
    v_mul_f32 v38, s91, v102
    v_mul_f32 v39, s91, v103
    v_exp_f32 v36, -v36
    v_exp_f32 v37, -v37
    v_exp_f32 v38, -v38
    v_exp_f32 v39, -v39
    v_add_f32 v36, 1.0, v36
    v_add_f32 v37, 1.0, v37
    v_add_f32 v38, 1.0, v38
    v_add_f32 v39, 1.0, v39
    v_rcp_f32 v36, v36
    v_rcp_f32 v37, v37
    v_rcp_f32 v38, v38
    v_rcp_f32 v39, v39
    v_mul_f32 v100, v100, v36
    v_mul_f32 v101, v101, v37
    v_mul_f32 v102, v102, v38
    v_mul_f32 v103, v103, v39
    s_waitcnt vmcnt(5)
    buffer_load_dwordx4 v[252:255], v2, s[32:35], s73 offen offset:3072 nt
    v_cvt_pk_bf16_f32 v100, v100, v100
    v_lshlrev_b32 v100, 16, v100
    v_cvt_pk_bf16_f32 v101, v101, v101
    v_lshlrev_b32 v101, 16, v101
    v_cvt_pk_bf16_f32 v102, v102, v102
    v_lshlrev_b32 v102, 16, v102
    v_cvt_pk_bf16_f32 v103, v103, v103
    v_lshlrev_b32 v103, 16, v103
    v_mul_f32 v100, v100, v32
    v_mul_f32 v101, v101, v33
    v_mul_f32 v102, v102, v34
    v_mul_f32 v103, v103, v35
    v_cvt_pk_bf16_f32 v100, v100, v100
    v_cvt_pk_bf16_f32 v101, v101, v101
    v_cvt_pk_bf16_f32 v102, v102, v102
    v_cvt_pk_bf16_f32 v103, v103, v103
    s_add_u32 s73, s72, 8388608
    s_waitcnt vmcnt(5)
    buffer_load_dwordx4 v[128:131], v2, s[32:35], s73 offen nt
    s_lshl_b32 s76, s3, 6
    s_add_u32 s76, s76, 5888
    v_mov_b32 v40, 0
    v_lshl_add_u32 v27, v30, 2, s76
    ds_write_b32 v27, v40
    v_lshl_add_u32 v32, v1, 2, 0
    v_mul_u32_u24 v36, 37, v32
    v_lshrrev_b32 v36, 8, v36
    v_add_u32 v32, v32, v36
    v_lshl_add_u32 v32, v32, 1, s76
    v_lshl_add_u32 v33, v1, 2, 1
    v_mul_u32_u24 v37, 37, v33
    v_lshrrev_b32 v37, 8, v37
    v_add_u32 v33, v33, v37
    v_lshl_add_u32 v33, v33, 1, s76
    v_lshl_add_u32 v34, v1, 2, 2
    v_mul_u32_u24 v38, 37, v34
    v_lshrrev_b32 v38, 8, v38
    v_add_u32 v34, v34, v38
    v_lshl_add_u32 v34, v34, 1, s76
    v_lshl_add_u32 v35, v1, 2, 3
    v_mul_u32_u24 v39, 37, v35
    v_lshrrev_b32 v39, 8, v39
    v_add_u32 v35, v35, v39
    v_lshl_add_u32 v35, v35, 1, s76
    s_mov_b64 exec, 0x7f
    ds_write_b16 v32, v100
    ds_write_b16 v33, v101
    ds_write_b16 v34, v102
    ds_write_b16 v35, v103
    s_mov_b64 exec, -1
    v_lshl_add_u32 v27, v31, 4, s76
    ds_read_b128 v[12:15], v27
    s_waitcnt lgkmcnt(0)
    v_perm_b32 v32, v196, v192, s82
    v_perm_b32 v33, v204, v200, s82
    v_perm_b32 v34, v212, v208, s82
    v_perm_b32 v35, v220, v216, s82
    v_perm_b32 v36, v196, v192, s83
    v_perm_b32 v37, v204, v200, s83
    v_perm_b32 v38, v212, v208, s83
    v_perm_b32 v39, v220, v216, s83
    v_mfma_f32_16x16x32_bf16 a[0:3], v[80:83], v[32:35], a[0:3]
    v_perm_b32 v40, v197, v193, s82
    v_perm_b32 v41, v205, v201, s82
    v_perm_b32 v42, v213, v209, s82
    v_perm_b32 v43, v221, v217, s82
    v_mfma_f32_16x16x32_bf16 a[4:7], v[80:83], v[36:39], a[4:7]
    v_perm_b32 v44, v197, v193, s83
    v_perm_b32 v45, v205, v201, s83
    v_perm_b32 v46, v213, v209, s83
    v_perm_b32 v47, v221, v217, s83
    v_mfma_f32_16x16x32_bf16 a[8:11], v[80:83], v[40:43], a[8:11]
    v_perm_b32 v48, v198, v194, s82
    v_perm_b32 v49, v206, v202, s82
    v_perm_b32 v50, v214, v210, s82
    v_perm_b32 v51, v222, v218, s82
    v_mfma_f32_16x16x32_bf16 a[12:15], v[80:83], v[44:47], a[12:15]
    s_waitcnt vmcnt(5)
    buffer_load_dwordx4 v[132:135], v2, s[32:35], s73 offen offset:1024 nt
    v_perm_b32 v52, v198, v194, s83
    v_perm_b32 v53, v206, v202, s83
    v_perm_b32 v54, v214, v210, s83
    v_perm_b32 v55, v222, v218, s83
    v_mfma_f32_16x16x32_bf16 a[16:19], v[80:83], v[48:51], a[16:19]
    v_perm_b32 v56, v199, v195, s82
    v_perm_b32 v57, v207, v203, s82
    v_perm_b32 v58, v215, v211, s82
    v_perm_b32 v59, v223, v219, s82
    v_mfma_f32_16x16x32_bf16 a[20:23], v[80:83], v[52:55], a[20:23]
    v_perm_b32 v60, v199, v195, s83
    v_perm_b32 v61, v207, v203, s83
    v_perm_b32 v62, v215, v211, s83
    v_perm_b32 v63, v223, v219, s83
    v_mfma_f32_16x16x32_bf16 a[24:27], v[80:83], v[56:59], a[24:27]
    s_nop 0
    v_mfma_f32_16x16x32_bf16 a[28:31], v[80:83], v[60:63], a[28:31]
    s_waitcnt vmcnt(5)
    buffer_load_dwordx4 v[136:139], v2, s[32:35], s73 offen offset:2048 nt
    s_waitcnt vmcnt(5)
    buffer_load_dwordx4 v[140:143], v2, s[32:35], s73 offen offset:3072 nt
    s_add_u32 s73, s72, 8912896
    s_waitcnt vmcnt(5)
    buffer_load_dwordx4 v[144:147], v2, s[32:35], s73 offen nt
    v_lshrrev_b32 v76, 2, v1
    v_lshlrev_b32 v76, 10, v76
    v_and_b32 v27, 3, v1
    v_lshl_add_u32 v76, v27, 7, v76
    s_lshl_b32 s10, s74, 14
    s_lshl_b32 s76, s3, 4
    s_add_u32 s10, s10, s76
    s_add_u32 s10, s10, 393728
    buffer_load_dwordx4 v[68:71], v76, s[56:59], s10 offen sc1
    s_waitcnt vmcnt(6)
    buffer_load_dwordx4 v[148:151], v2, s[32:35], s73 offen offset:1024 nt
    v_perm_b32 v32, v228, v224, s82
    v_perm_b32 v33, v236, v232, s82
    v_perm_b32 v34, v244, v240, s82
    v_perm_b32 v35, v252, v248, s82
    v_perm_b32 v36, v228, v224, s83
    v_perm_b32 v37, v236, v232, s83
    v_perm_b32 v38, v244, v240, s83
    v_perm_b32 v39, v252, v248, s83
    v_mfma_f32_16x16x32_bf16 a[0:3], v[88:91], v[32:35], a[0:3]
    v_perm_b32 v40, v229, v225, s82
    v_perm_b32 v41, v237, v233, s82
    v_perm_b32 v42, v245, v241, s82
    v_perm_b32 v43, v253, v249, s82
    v_mfma_f32_16x16x32_bf16 a[4:7], v[88:91], v[36:39], a[4:7]
    v_perm_b32 v44, v229, v225, s83
    v_perm_b32 v45, v237, v233, s83
    v_perm_b32 v46, v245, v241, s83
    v_perm_b32 v47, v253, v249, s83
    v_mfma_f32_16x16x32_bf16 a[8:11], v[88:91], v[40:43], a[8:11]
    v_perm_b32 v48, v230, v226, s82
    v_perm_b32 v49, v238, v234, s82
    v_perm_b32 v50, v246, v242, s82
    v_perm_b32 v51, v254, v250, s82
    v_mfma_f32_16x16x32_bf16 a[12:15], v[88:91], v[44:47], a[12:15]
    s_waitcnt vmcnt(6)
    buffer_load_dwordx4 v[152:155], v2, s[32:35], s73 offen offset:2048 nt
    v_perm_b32 v52, v230, v226, s83
    v_perm_b32 v53, v238, v234, s83
    v_perm_b32 v54, v246, v242, s83
    v_perm_b32 v55, v254, v250, s83
    v_mfma_f32_16x16x32_bf16 a[16:19], v[88:91], v[48:51], a[16:19]
    v_perm_b32 v56, v231, v227, s82
    v_perm_b32 v57, v239, v235, s82
    v_perm_b32 v58, v247, v243, s82
    v_perm_b32 v59, v255, v251, s82
    v_mfma_f32_16x16x32_bf16 a[20:23], v[88:91], v[52:55], a[20:23]
    v_perm_b32 v60, v231, v227, s83
    v_perm_b32 v61, v239, v235, s83
    v_perm_b32 v62, v247, v243, s83
    v_perm_b32 v63, v255, v251, s83
    v_mfma_f32_16x16x32_bf16 a[24:27], v[88:91], v[56:59], a[24:27]
    s_nop 0
    v_mfma_f32_16x16x32_bf16 a[28:31], v[88:91], v[60:63], a[28:31]
    s_waitcnt vmcnt(6)
    buffer_load_dwordx4 v[156:159], v2, s[32:35], s73 offen offset:3072 nt
    s_add_u32 s73, s72, 8454144
    s_waitcnt vmcnt(6)
    buffer_load_dwordx4 v[160:163], v2, s[32:35], s73 offen nt
    s_waitcnt vmcnt(6)
    buffer_load_dwordx4 v[164:167], v2, s[32:35], s73 offen offset:1024 nt
    s_waitcnt vmcnt(6)
    buffer_load_dwordx4 v[168:171], v2, s[32:35], s73 offen offset:2048 nt
    s_lshl_b32 s76, s3, 5
    s_add_u32 s76, s76, 5120
    v_and_b32 v28, 1, v1
    v_lshl_add_u32 v84, v28, 4, s76
    v_bfe_u32 v85, v1, 1, 2
    v_lshl_add_u32 v84, v85, 2, v84
    ds_read_b32 v84, v84
    s_waitcnt vmcnt(6)
    v_xor_b32 v68, v5, v68
    v_xor_b32 v69, v5, v69
    v_xor_b32 v70, v5, v70
    v_xor_b32 v71, v5, v71
    v_or3_b32 v27, v68, v69, v70
    v_or_b32 v27, v27, v71
    v_and_b32 v27, 0xff, v27
    v_cmp_ne_u32 vcc, 0, v27
    s_cbranch_vccnz L_stats_retry_12
L_stats_ok_13:
    s_waitcnt vmcnt(5)
    buffer_load_dwordx4 v[172:175], v2, s[32:35], s73 offen offset:3072 nt
    v_mov_b32 v77, v68
    v_mov_b32 v78, v70
    s_nop 0
    v_max_f32_dpp v77, v77, v77 row_ror:8 row_mask:0xf bank_mask:0xf
    v_max_f32_dpp v78, v78, v78 row_ror:8 row_mask:0xf bank_mask:0xf
    s_nop 0
    v_max_f32_dpp v77, v77, v77 row_ror:4 row_mask:0xf bank_mask:0xf
    v_max_f32_dpp v78, v78, v78 row_ror:4 row_mask:0xf bank_mask:0xf
    s_nop 0
    v_max_f32_dpp v77, v77, v77 row_ror:2 row_mask:0xf bank_mask:0xf
    v_max_f32_dpp v78, v78, v78 row_ror:2 row_mask:0xf bank_mask:0xf
    s_nop 0
    v_max_f32_dpp v77, v77, v77 row_ror:1 row_mask:0xf bank_mask:0xf
    v_max_f32_dpp v78, v78, v78 row_ror:1 row_mask:0xf bank_mask:0xf
    v_mov_b32 v27, v77
    s_nop 1
    v_permlane16_swap_b32 v77, v27
    v_max_f32 v77, v77, v27
    v_mov_b32 v79, v78
    s_nop 1
    v_permlane16_swap_b32 v78, v79
    v_max_f32 v78, v78, v79
    v_mov_b32 v27, v77
    s_nop 1
    v_permlane32_swap_b32 v77, v27
    v_max_f32 v77, v77, v27
    v_mov_b32 v79, v78
    s_nop 1
    v_permlane32_swap_b32 v78, v79
    v_max_f32 v78, v78, v79
    s_add_u32 s73, s72, 8978432
    s_waitcnt vmcnt(5)
    buffer_load_dwordx4 v[176:179], v2, s[32:35], s73 offen nt
    v_sub_f32 v68, v68, v77
    v_sub_f32 v70, v70, v78
    v_mul_f32 v68, s91, v68
    v_mul_f32 v70, s91, v70
    v_exp_f32 v68, v68
    v_exp_f32 v70, v70
    v_mul_f32 v69, v68, v69
    v_mul_f32 v71, v70, v71
    s_nop 0
    v_add_f32_dpp v69, v69, v69 row_ror:8 row_mask:0xf bank_mask:0xf
    v_add_f32_dpp v71, v71, v71 row_ror:8 row_mask:0xf bank_mask:0xf
    s_nop 0
    v_add_f32_dpp v69, v69, v69 row_ror:4 row_mask:0xf bank_mask:0xf
    v_add_f32_dpp v71, v71, v71 row_ror:4 row_mask:0xf bank_mask:0xf
    s_nop 0
    v_add_f32_dpp v69, v69, v69 row_ror:2 row_mask:0xf bank_mask:0xf
    v_add_f32_dpp v71, v71, v71 row_ror:2 row_mask:0xf bank_mask:0xf
    s_nop 0
    v_add_f32_dpp v69, v69, v69 row_ror:1 row_mask:0xf bank_mask:0xf
    v_add_f32_dpp v71, v71, v71 row_ror:1 row_mask:0xf bank_mask:0xf
    v_mov_b32 v27, v69
    s_nop 1
    v_permlane16_swap_b32 v69, v27
    v_add_f32 v69, v69, v27
    v_mov_b32 v79, v71
    s_nop 1
    v_permlane16_swap_b32 v71, v79
    v_add_f32 v71, v71, v79
    v_mov_b32 v27, v69
    s_nop 1
    v_permlane32_swap_b32 v69, v27
    v_add_f32 v69, v69, v27
    v_mov_b32 v79, v71
    s_nop 1
    v_permlane32_swap_b32 v71, v79
    v_add_f32 v71, v71, v79
    s_waitcnt vmcnt(5)
    buffer_load_dwordx4 v[180:183], v2, s[32:35], s73 offen offset:1024 nt
    v_cmp_eq_u32 vcc, 1, v28
    s_nop 1
    v_cndmask_b32 v77, v77, v78, vcc
    v_cndmask_b32 v69, v69, v71, vcc
    v_rcp_f32 v69, v69
    s_waitcnt lgkmcnt(0)
    v_sub_f32 v77, v84, v77
    v_mul_f32 v77, s91, v77
    v_exp_f32 v77, v77
    s_lshl_b32 s76, s3, 3
    s_add_u32 s76, s76, 5632
    v_lshl_add_u32 v27, v28, 2, s76
    v_lshl_add_u32 v27, v85, 6, v27
    v_mul_f32 v77, v77, v69
    ds_write_b32 v27, v77
    s_lshl_b32 s11, s74, 6
    s_add_u32 s11, s11, s75
    s_mul_i32 s11, s11, 4224
    s_lshl_b32 s76, s3, 10
    s_add_u32 s11, s11, s76
    s_add_u32 s11, s11, 524288
    v_lshrrev_b32 v92, 3, v1
    v_mul_u32_u24 v92, 4224, v92
    v_and_b32 v27, 7, v1
    v_lshl_add_u32 v92, v27, 4, v92
    s_lshl_b32 s76, s74, 6
    s_lshl_b32 s77, s3, 4
    s_add_u32 s76, s76, s77
    s_mul_i32 s76, s76, 4224
    s_and_b32 s77, s88, 31
    s_lshl_b32 s77, s77, 7
    s_add_u32 s76, s76, s77
    s_add_u32 s12, s76, 524288
    s_add_u32 s13, s12, 33792
    s_waitcnt vmcnt(5)
    buffer_load_dwordx4 v[184:187], v2, s[32:35], s73 offen offset:2048 nt
    s_mul_i32 s76, s88, 4224
    s_lshl_b32 s77, s89, 1
    s_add_u32 s76, s76, s77
    s_add_u32 s76, s76, 1605632
    v_lshl_add_u32 v93, v30, 5, s76
    v_and_b32 v28, 16, v1
    v_add_u32 v93, v93, v28
    s_mul_i32 s76, s8, 4224
    s_lshl_b32 s77, s7, 9
    s_add_u32 s76, s76, s77
    s_lshl_b32 s77, s3, 7
    s_add_u32 s76, s76, s77
    s_add_u32 s76, s76, 2146304
    v_lshl_add_u32 v28, v27, 4, s76
    v_cmp_lt_u32 vcc, 31, v1
    s_nop 1
    v_cndmask_b32 v93, v93, v28, vcc
    s_mul_i32 s76, s23, 4224
    s_lshl_b32 s77, s22, 9
    s_add_u32 s76, s76, s77
    s_lshl_b32 s77, s3, 7
    s_add_u32 s76, s76, s77
    s_add_u32 s76, s76, 2146304
    v_lshl_add_u32 v28, v27, 4, s76
    v_cmp_lt_u32 vcc, 39, v1
    s_nop 1
    v_cndmask_b32 v93, v93, v28, vcc
    s_waitcnt vmcnt(5)
    buffer_load_dwordx4 v[188:191], v2, s[32:35], s73 offen offset:3072 nt
    s_lshl_b32 s76, s3, 2
    s_add_u32 s76, s76, 6144
    v_lshl_add_u32 v86, v27, 2, v31
    v_lshl_add_u32 v86, v86, 4, s76
    v_lshl_add_u32 v87, v31, 3, v27
    v_lshlrev_b32 v87, 4, v87
    v_and_b32 v28, 8, v1
    v_add_u32 v87, v87, v28
    s_lshl_b32 s76, s3, 7
    v_lshl_add_u32 v76, v27, 4, s76
    v_lshl_add_u32 v76, v28, 8, v76
    s_add_u32 s73, s72, 12582912
    s_waitcnt vmcnt(5)
    buffer_load_dwordx4 v[192:195], v2, s[32:35], s73 offen nt
    v_lshrrev_b32 v28, 2, v1
    v_mul_u32_u24 v94, 4224, v28
    v_and_b32 v27, 3, v1
    v_lshl_add_u32 v94, v27, 4, v94
    v_and_b32 v28, 7, v28
    v_mul_u32_u24 v95, 4224, v28
    v_lshl_add_u32 v95, v27, 4, v95
    s_lshl_b32 s76, s90, 6
    s_mul_i32 s77, s3, 135168
    s_add_u32 s77, s77, s76
    s_add_u32 s16, s77, 1605632
    s_add_u32 s17, s77, 1673216
    s_mul_i32 s77, s3, 33792
    s_add_u32 s77, s77, s76
    s_add_u32 s15, s77, 2146304
    s_lshl_b32 s20, s90, 5
    v_perm_b32 v32, v132, v128, s82
    v_perm_b32 v33, v140, v136, s82
    v_perm_b32 v34, v148, v144, s82
    v_perm_b32 v35, v156, v152, s82
    v_perm_b32 v36, v132, v128, s83
    v_perm_b32 v37, v140, v136, s83
    v_perm_b32 v38, v148, v144, s83
    v_perm_b32 v39, v156, v152, s83
    v_mfma_f32_16x16x32_bf16 a[0:3], v[96:99], v[32:35], a[0:3]
    v_perm_b32 v40, v133, v129, s82
    v_perm_b32 v41, v141, v137, s82
    v_perm_b32 v42, v149, v145, s82
    v_perm_b32 v43, v157, v153, s82
    v_mfma_f32_16x16x32_bf16 a[4:7], v[96:99], v[36:39], a[4:7]
    v_perm_b32 v44, v133, v129, s83
    v_perm_b32 v45, v141, v137, s83
    v_perm_b32 v46, v149, v145, s83
    v_perm_b32 v47, v157, v153, s83
    v_mfma_f32_16x16x32_bf16 a[8:11], v[96:99], v[40:43], a[8:11]
    v_perm_b32 v48, v134, v130, s82
    v_perm_b32 v49, v142, v138, s82
    v_perm_b32 v50, v150, v146, s82
    v_perm_b32 v51, v158, v154, s82
    v_mfma_f32_16x16x32_bf16 a[12:15], v[96:99], v[44:47], a[12:15]
    s_waitcnt vmcnt(5)
    buffer_load_dwordx4 v[196:199], v2, s[32:35], s73 offen offset:1024 nt
    v_perm_b32 v52, v134, v130, s83
    v_perm_b32 v53, v142, v138, s83
    v_perm_b32 v54, v150, v146, s83
    v_perm_b32 v55, v158, v154, s83
    v_mfma_f32_16x16x32_bf16 a[16:19], v[96:99], v[48:51], a[16:19]
    v_perm_b32 v56, v135, v131, s82
    v_perm_b32 v57, v143, v139, s82
    v_perm_b32 v58, v151, v147, s82
    v_perm_b32 v59, v159, v155, s82
    v_mfma_f32_16x16x32_bf16 a[20:23], v[96:99], v[52:55], a[20:23]
    v_perm_b32 v60, v135, v131, s83
    v_perm_b32 v61, v143, v139, s83
    v_perm_b32 v62, v151, v147, s83
    v_perm_b32 v63, v159, v155, s83
    v_mfma_f32_16x16x32_bf16 a[24:27], v[96:99], v[56:59], a[24:27]
    s_nop 0
    v_mfma_f32_16x16x32_bf16 a[28:31], v[96:99], v[60:63], a[28:31]
    s_waitcnt vmcnt(5)
    buffer_load_dwordx4 v[200:203], v2, s[32:35], s73 offen offset:2048 nt
    s_cmp_lg_u32 s93, 0
    s_cbranch_scc1 L_skip_14
    v_xor_b32 v108, v5, v108
    v_xor_b32 v109, v5, v109
    v_xor_b32 v110, v5, v110
    v_xor_b32 v111, v5, v111
    v_or3_b32 v27, v108, v109, v110
    v_or_b32 v27, v27, v111
    v_and_b32 v27, 0xff, v27
    v_cmp_ne_u32 vcc, 0, v27
    s_cbranch_vccnz L_h_retry_15
L_h_ok_16:
    v_add_f32_dpp v108, v108, v108 row_ror:8 row_mask:0xf bank_mask:0xf
    v_add_f32_dpp v109, v109, v109 row_ror:8 row_mask:0xf bank_mask:0xf
    v_add_f32_dpp v110, v110, v110 row_ror:8 row_mask:0xf bank_mask:0xf
    v_add_f32_dpp v111, v111, v111 row_ror:8 row_mask:0xf bank_mask:0xf
    v_mov_b32 v32, v108
    s_nop 1
    v_permlane16_swap_b32 v108, v32
    v_add_f32 v108, v108, v32
    v_mov_b32 v33, v109
    s_nop 1
    v_permlane16_swap_b32 v109, v33
    v_add_f32 v109, v109, v33
    v_mov_b32 v34, v110
    s_nop 1
    v_permlane16_swap_b32 v110, v34
    v_add_f32 v110, v110, v34
    v_mov_b32 v35, v111
    s_nop 1
    v_permlane16_swap_b32 v111, v35
    v_add_f32 v111, v111, v35
    v_cvt_pk_bf16_f32 v108, v108, v108
    v_lshlrev_b32 v108, 16, v108
    v_cvt_pk_bf16_f32 v109, v109, v109
    v_lshlrev_b32 v109, 16, v109
    v_cvt_pk_bf16_f32 v110, v110, v110
    v_lshlrev_b32 v110, 16, v110
    v_cvt_pk_bf16_f32 v111, v111, v111
    v_lshlrev_b32 v111, 16, v111
    v_mov_b32 v32, v108
    v_mov_b32 v33, v109
    v_mov_b32 v34, v110
    v_mov_b32 v35, v111
    v_permlane32_swap_b32 v108, v32
    v_permlane32_swap_b32 v109, v33
    v_permlane32_swap_b32 v110, v34
    v_permlane32_swap_b32 v111, v35
    v_mul_f32 v36, s91, v108
    v_mul_f32 v37, s91, v109
    v_mul_f32 v38, s91, v110
    v_mul_f32 v39, s91, v111
    v_exp_f32 v36, -v36
    v_exp_f32 v37, -v37
    v_exp_f32 v38, -v38
    v_exp_f32 v39, -v39
    v_add_f32 v36, 1.0, v36
    v_add_f32 v37, 1.0, v37
    v_add_f32 v38, 1.0, v38
    v_add_f32 v39, 1.0, v39
    v_rcp_f32 v36, v36
    v_rcp_f32 v37, v37
    v_rcp_f32 v38, v38
    v_rcp_f32 v39, v39
    v_mul_f32 v108, v108, v36
    v_mul_f32 v109, v109, v37
    v_mul_f32 v110, v110, v38
    v_mul_f32 v111, v111, v39
    v_cvt_pk_bf16_f32 v108, v108, v108
    v_lshlrev_b32 v108, 16, v108
    v_cvt_pk_bf16_f32 v109, v109, v109
    v_lshlrev_b32 v109, 16, v109
    v_cvt_pk_bf16_f32 v110, v110, v110
    v_lshlrev_b32 v110, 16, v110
    v_cvt_pk_bf16_f32 v111, v111, v111
    v_lshlrev_b32 v111, 16, v111
    v_mul_f32 v108, v108, v32
    v_mul_f32 v109, v109, v33
    v_mul_f32 v110, v110, v34
    v_mul_f32 v111, v111, v35
    v_cvt_pk_bf16_f32 v108, v108, v108
    v_cvt_pk_bf16_f32 v109, v109, v109
    v_cvt_pk_bf16_f32 v110, v110, v110
    v_cvt_pk_bf16_f32 v111, v111, v111
    s_lshl_b32 s76, s3, 6
    s_add_u32 s76, s76, 5888
    v_mov_b32 v40, 0
    v_lshl_add_u32 v27, v30, 2, s76
    ds_write_b32 v27, v40
    v_lshl_add_u32 v32, v1, 2, 0
    v_mul_u32_u24 v36, 37, v32
    v_lshrrev_b32 v36, 8, v36
    v_add_u32 v32, v32, v36
    v_lshl_add_u32 v32, v32, 1, s76
    v_lshl_add_u32 v33, v1, 2, 1
    v_mul_u32_u24 v37, 37, v33
    v_lshrrev_b32 v37, 8, v37
    v_add_u32 v33, v33, v37
    v_lshl_add_u32 v33, v33, 1, s76
    v_lshl_add_u32 v34, v1, 2, 2
    v_mul_u32_u24 v38, 37, v34
    v_lshrrev_b32 v38, 8, v38
    v_add_u32 v34, v34, v38
    v_lshl_add_u32 v34, v34, 1, s76
    v_lshl_add_u32 v35, v1, 2, 3
    v_mul_u32_u24 v39, 37, v35
    v_lshrrev_b32 v39, 8, v39
    v_add_u32 v35, v35, v39
    v_lshl_add_u32 v35, v35, 1, s76
    s_mov_b64 exec, 0x7f
    ds_write_b16 v32, v108
    ds_write_b16 v33, v109
    ds_write_b16 v34, v110
    ds_write_b16 v35, v111
    s_mov_b64 exec, -1
    v_lshl_add_u32 v27, v31, 4, s76
    ds_read_b128 v[16:19], v27
    s_waitcnt lgkmcnt(0)
L_skip_14:
    s_waitcnt vmcnt(5)
    buffer_load_dwordx4 v[204:207], v2, s[32:35], s73 offen offset:3072 nt
    s_add_u32 s73, s72, 13107200
    s_waitcnt vmcnt(5)
    buffer_load_dwordx4 v[208:211], v2, s[32:35], s73 offen nt
    s_waitcnt vmcnt(5)
    buffer_load_dwordx4 v[212:215], v2, s[32:35], s73 offen offset:1024 nt
    v_perm_b32 v32, v164, v160, s82
    v_perm_b32 v33, v172, v168, s82
    v_perm_b32 v34, v180, v176, s82
    v_perm_b32 v35, v188, v184, s82
    v_perm_b32 v36, v164, v160, s83
    v_perm_b32 v37, v172, v168, s83
    v_perm_b32 v38, v180, v176, s83
    v_perm_b32 v39, v188, v184, s83
    v_mfma_f32_16x16x32_bf16 a[0:3], v[104:107], v[32:35], a[0:3]
    v_perm_b32 v40, v165, v161, s82
    v_perm_b32 v41, v173, v169, s82
    v_perm_b32 v42, v181, v177, s82
    v_perm_b32 v43, v189, v185, s82
    v_mfma_f32_16x16x32_bf16 a[4:7], v[104:107], v[36:39], a[4:7]
    v_perm_b32 v44, v165, v161, s83
    v_perm_b32 v45, v173, v169, s83
    v_perm_b32 v46, v181, v177, s83
    v_perm_b32 v47, v189, v185, s83
    v_mfma_f32_16x16x32_bf16 a[8:11], v[104:107], v[40:43], a[8:11]
    v_perm_b32 v48, v166, v162, s82
    v_perm_b32 v49, v174, v170, s82
    v_perm_b32 v50, v182, v178, s82
    v_perm_b32 v51, v190, v186, s82
    v_mfma_f32_16x16x32_bf16 a[12:15], v[104:107], v[44:47], a[12:15]
    s_waitcnt vmcnt(5)
    buffer_load_dwordx4 v[216:219], v2, s[32:35], s73 offen offset:2048 nt
    v_perm_b32 v52, v166, v162, s83
    v_perm_b32 v53, v174, v170, s83
    v_perm_b32 v54, v182, v178, s83
    v_perm_b32 v55, v190, v186, s83
    v_mfma_f32_16x16x32_bf16 a[16:19], v[104:107], v[48:51], a[16:19]
    v_perm_b32 v56, v167, v163, s82
    v_perm_b32 v57, v175, v171, s82
    v_perm_b32 v58, v183, v179, s82
    v_perm_b32 v59, v191, v187, s82
    v_mfma_f32_16x16x32_bf16 a[20:23], v[104:107], v[52:55], a[20:23]
    v_perm_b32 v60, v167, v163, s83
    v_perm_b32 v61, v175, v171, s83
    v_perm_b32 v62, v183, v179, s83
    v_perm_b32 v63, v191, v187, s83
    v_mfma_f32_16x16x32_bf16 a[24:27], v[104:107], v[56:59], a[24:27]
    s_nop 0
    v_mfma_f32_16x16x32_bf16 a[28:31], v[104:107], v[60:63], a[28:31]
    s_waitcnt vmcnt(5)
    buffer_load_dwordx4 v[220:223], v2, s[32:35], s73 offen offset:3072 nt
    s_add_u32 s73, s72, 12648448
    s_waitcnt vmcnt(5)
    buffer_load_dwordx4 v[224:227], v2, s[32:35], s73 offen nt
    s_waitcnt vmcnt(5)
    buffer_load_dwordx4 v[228:231], v2, s[32:35], s73 offen offset:1024 nt
    s_waitcnt vmcnt(5)
    buffer_load_dwordx4 v[232:235], v2, s[32:35], s73 offen offset:2048 nt
    s_waitcnt vmcnt(5)
    buffer_load_dwordx4 v[236:239], v2, s[32:35], s73 offen offset:3072 nt
    s_add_u32 s73, s72, 13172736
    s_waitcnt vmcnt(5)
    buffer_load_dwordx4 v[240:243], v2, s[32:35], s73 offen nt
    s_waitcnt vmcnt(5)
    buffer_load_dwordx4 v[244:247], v2, s[32:35], s73 offen offset:1024 nt
    v_perm_b32 v32, v196, v192, s82
    v_perm_b32 v33, v204, v200, s82
    v_perm_b32 v34, v212, v208, s82
    v_perm_b32 v35, v220, v216, s82
    v_perm_b32 v36, v196, v192, s83
    v_perm_b32 v37, v204, v200, s83
    v_perm_b32 v38, v212, v208, s83
    v_perm_b32 v39, v220, v216, s83
    v_mfma_f32_16x16x32_bf16 a[0:3], v[112:115], v[32:35], a[0:3]
    v_perm_b32 v40, v197, v193, s82
    v_perm_b32 v41, v205, v201, s82
    v_perm_b32 v42, v213, v209, s82
    v_perm_b32 v43, v221, v217, s82
    v_mfma_f32_16x16x32_bf16 a[4:7], v[112:115], v[36:39], a[4:7]
    v_perm_b32 v44, v197, v193, s83
    v_perm_b32 v45, v205, v201, s83
    v_perm_b32 v46, v213, v209, s83
    v_perm_b32 v47, v221, v217, s83
    v_mfma_f32_16x16x32_bf16 a[8:11], v[112:115], v[40:43], a[8:11]
    v_perm_b32 v48, v198, v194, s82
    v_perm_b32 v49, v206, v202, s82
    v_perm_b32 v50, v214, v210, s82
    v_perm_b32 v51, v222, v218, s82
    v_mfma_f32_16x16x32_bf16 a[12:15], v[112:115], v[44:47], a[12:15]
    s_waitcnt vmcnt(5)
    buffer_load_dwordx4 v[248:251], v2, s[32:35], s73 offen offset:2048 nt
    v_perm_b32 v52, v198, v194, s83
    v_perm_b32 v53, v206, v202, s83
    v_perm_b32 v54, v214, v210, s83
    v_perm_b32 v55, v222, v218, s83
    v_mfma_f32_16x16x32_bf16 a[16:19], v[112:115], v[48:51], a[16:19]
    v_perm_b32 v56, v199, v195, s82
    v_perm_b32 v57, v207, v203, s82
    v_perm_b32 v58, v215, v211, s82
    v_perm_b32 v59, v223, v219, s82
    v_mfma_f32_16x16x32_bf16 a[20:23], v[112:115], v[52:55], a[20:23]
    v_perm_b32 v60, v199, v195, s83
    v_perm_b32 v61, v207, v203, s83
    v_perm_b32 v62, v215, v211, s83
    v_perm_b32 v63, v223, v219, s83
    v_mfma_f32_16x16x32_bf16 a[24:27], v[112:115], v[56:59], a[24:27]
    s_nop 0
    v_mfma_f32_16x16x32_bf16 a[28:31], v[112:115], v[60:63], a[28:31]
    s_waitcnt vmcnt(5)
    buffer_load_dwordx4 v[252:255], v2, s[32:35], s73 offen offset:3072 nt
    s_cmp_eq_u32 s21, 1
    s_cbranch_scc1 L_role1
    s_cmp_eq_u32 s21, 2
    s_cbranch_scc1 L_role2
    s_add_u32 s73, s81, 0
    s_waitcnt vmcnt(5)
    buffer_load_dwordx4 v[160:163], v7, s[40:43], s73 offen nt
    v_perm_b32 v32, v228, v224, s82
    v_perm_b32 v36, v228, v224, s83
    v_perm_b32 v40, v229, v225, s82
    v_perm_b32 v44, v229, v225, s83
    v_perm_b32 v48, v230, v226, s82
    v_perm_b32 v52, v230, v226, s83
    v_perm_b32 v56, v231, v227, s82
    v_perm_b32 v60, v231, v227, s83
    s_add_u32 s73, s81, 262144
    s_waitcnt vmcnt(5)
    buffer_load_dwordx4 v[164:167], v7, s[40:43], s73 offen nt
    v_perm_b32 v33, v236, v232, s82
    v_perm_b32 v37, v236, v232, s83
    v_perm_b32 v41, v237, v233, s82
    v_perm_b32 v45, v237, v233, s83
    v_perm_b32 v49, v238, v234, s82
    v_perm_b32 v53, v238, v234, s83
    v_perm_b32 v57, v239, v235, s82
    v_perm_b32 v61, v239, v235, s83
    s_add_u32 s73, s81, 524288
    s_waitcnt vmcnt(5)
    buffer_load_dwordx4 v[168:171], v7, s[40:43], s73 offen nt
    s_waitcnt vmcnt(5)
    v_perm_b32 v34, v244, v240, s82
    v_perm_b32 v38, v244, v240, s83
    v_perm_b32 v42, v245, v241, s82
    v_perm_b32 v46, v245, v241, s83
    v_perm_b32 v50, v246, v242, s82
    v_perm_b32 v54, v246, v242, s83
    v_perm_b32 v58, v247, v243, s82
    v_perm_b32 v62, v247, v243, s83
    s_waitcnt vmcnt(3)
    v_perm_b32 v35, v252, v248, s82
    v_perm_b32 v39, v252, v248, s83
    s_nop 0
    v_mfma_f32_16x16x32_bf16 a[0:3], v[120:123], v[32:35], a[0:3]
    v_perm_b32 v43, v253, v249, s82
    v_mfma_f32_16x16x32_bf16 a[4:7], v[120:123], v[36:39], a[4:7]
    v_perm_b32 v47, v253, v249, s83
    v_mfma_f32_16x16x32_bf16 a[8:11], v[120:123], v[40:43], a[8:11]
    v_perm_b32 v51, v254, v250, s82
    v_mfma_f32_16x16x32_bf16 a[12:15], v[120:123], v[44:47], a[12:15]
    v_perm_b32 v55, v254, v250, s83
    v_mfma_f32_16x16x32_bf16 a[16:19], v[120:123], v[48:51], a[16:19]
    v_perm_b32 v59, v255, v251, s82
    v_mfma_f32_16x16x32_bf16 a[20:23], v[120:123], v[52:55], a[20:23]
    v_perm_b32 v63, v255, v251, s83
    v_mfma_f32_16x16x32_bf16 a[24:27], v[120:123], v[56:59], a[24:27]
    s_nop 0
    v_mfma_f32_16x16x32_bf16 a[28:31], v[120:123], v[60:63], a[28:31]
    s_lshl_b32 s76, s3, 12
    s_add_u32 s76, s76, 8192
    v_add_u32 v27, s76, v2
    s_mov_b32 exec_hi, 0
    ds_write_b128 v27, a[0:3] offset:0
    ds_write_b128 v27, a[4:7] offset:512
    ds_write_b128 v27, a[8:11] offset:1024
    ds_write_b128 v27, a[12:15] offset:1536
    ds_write_b128 v27, a[16:19] offset:2048
    ds_write_b128 v27, a[20:23] offset:2560
    ds_write_b128 v27, a[24:27] offset:3072
    ds_write_b128 v27, a[28:31] offset:3584
    s_mov_b64 exec, -1
    s_lshl_b32 s76, s3, 10
    s_add_u32 s77, s76, 8192
    v_add_u32 v27, s77, v2
    v_and_b32 v28, 16, v1
    s_waitcnt lgkmcnt(0)
    s_barrier
    ds_read_b128 v[32:35], v27 offset:0
    ds_read_b128 v[48:51], v28 offset:5632
    ds_read_b128 v[36:39], v27 offset:4096
    ds_read_b128 v[52:55], v28 offset:5696
    ds_read_b128 v[40:43], v27 offset:8192
    ds_read_b128 v[56:59], v28 offset:5760
    ds_read_b128 v[44:47], v27 offset:12288
    ds_read_b128 v[60:63], v28 offset:5824
    s_waitcnt lgkmcnt(6)
    v_mul_f32 v32, v32, v48
    v_mul_f32 v33, v33, v49
    v_mul_f32 v34, v34, v50
    v_mul_f32 v35, v35, v51
    s_waitcnt lgkmcnt(4)
    v_fmac_f32 v32, v36, v52
    v_fmac_f32 v33, v37, v53
    v_fmac_f32 v34, v38, v54
    v_fmac_f32 v35, v39, v55
    s_waitcnt lgkmcnt(2)
    v_fmac_f32 v32, v40, v56
    v_fmac_f32 v33, v41, v57
    v_fmac_f32 v34, v42, v58
    v_fmac_f32 v35, v43, v59
    s_waitcnt lgkmcnt(0)
    v_fmac_f32 v32, v44, v60
    v_fmac_f32 v33, v45, v61
    v_fmac_f32 v34, v46, v62
    v_fmac_f32 v35, v47, v63
    v_and_or_b32 v32, v32, s6, v5
    v_and_or_b32 v33, v33, s6, v5
    v_and_or_b32 v34, v34, s6, v5
    v_and_or_b32 v35, v35, s6, v5
    buffer_store_dwordx4 v[32:35], v2, s[56:59], s11 offen sc1
    s_add_u32 s73, s81, 786432
    buffer_load_dwordx4 v[172:175], v7, s[40:43], s73 offen nt
    s_add_u32 s73, s81, 16384
    buffer_load_dwordx4 v[176:179], v7, s[40:43], s73 offen nt
    s_add_u32 s73, s81, 278528
    buffer_load_dwordx4 v[180:183], v7, s[40:43], s73 offen nt
    s_add_u32 s73, s81, 540672
    buffer_load_dwordx4 v[184:187], v7, s[40:43], s73 offen nt
    s_add_u32 s73, s81, 802816
    buffer_load_dwordx4 v[188:191], v7, s[40:43], s73 offen nt
    s_waitcnt vmcnt(7)
    buffer_load_dwordx4 v[240:243], v92, s[56:59], s12 offen sc1
    buffer_load_dwordx4 v[244:247], v92, s[56:59], s13 offen sc1
    v_perm_b32 v32, v164, v160, s82
    v_perm_b32 v36, v164, v160, s83
    v_perm_b32 v40, v165, v161, s82
    v_perm_b32 v44, v165, v161, s83
    v_perm_b32 v48, v166, v162, s82
    v_perm_b32 v52, v166, v162, s83
    v_perm_b32 v56, v167, v163, s82
    v_perm_b32 v60, v167, v163, s83
    s_waitcnt vmcnt(6)
    v_perm_b32 v33, v172, v168, s82
    v_perm_b32 v37, v172, v168, s83
    v_perm_b32 v41, v173, v169, s82
    v_perm_b32 v45, v173, v169, s83
    v_perm_b32 v49, v174, v170, s82
    v_perm_b32 v53, v174, v170, s83
    v_perm_b32 v57, v175, v171, s82
    v_perm_b32 v61, v175, v171, s83
    s_waitcnt vmcnt(4)
    v_perm_b32 v34, v180, v176, s82
    v_perm_b32 v38, v180, v176, s83
    v_perm_b32 v42, v181, v177, s82
    v_perm_b32 v46, v181, v177, s83
    v_perm_b32 v50, v182, v178, s82
    v_perm_b32 v54, v182, v178, s83
    v_perm_b32 v58, v183, v179, s82
    v_perm_b32 v62, v183, v179, s83
    s_waitcnt vmcnt(0)
    v_xor_b32 v240, v5, v240
    v_xor_b32 v241, v5, v241
    v_xor_b32 v242, v5, v242
    v_xor_b32 v243, v5, v243
    v_xor_b32 v244, v5, v244
    v_xor_b32 v245, v5, v245
    v_xor_b32 v246, v5, v246
    v_xor_b32 v247, v5, v247
    v_or3_b32 v27, v240, v241, v242
    v_or3_b32 v27, v27, v243, v244
    v_or3_b32 v27, v27, v245, v246
    v_or_b32 v27, v27, v247
    v_and_b32 v27, 0xff, v27
    v_cmp_ne_u32 vcc, 0, v27
    s_cbranch_vccnz L_og_retry_17
L_og_ok_18:
    v_add_f32 v240, v240, v244
    v_add_f32 v241, v241, v245
    v_add_f32 v242, v242, v246
    v_add_f32 v243, v243, v247
    s_nop 0
    v_permlane32_swap_b32 v240, v242
    v_permlane32_swap_b32 v241, v243
    v_add_f32 v240, v240, v242
    v_add_f32 v241, v241, v243
    s_nop 1
    v_permlane16_swap_b32 v240, v241
    v_add_f32 v240, v240, v241
    s_nop 1
    v_add_f32_dpp v240, v240, v240 row_ror:8 row_mask:0xf bank_mask:0xf
    ds_write_b32 v86, v240
    v_perm_b32 v35, v188, v184, s82
    v_perm_b32 v39, v188, v184, s83
    v_perm_b32 v43, v189, v185, s82
    v_perm_b32 v47, v189, v185, s83
    v_perm_b32 v51, v190, v186, s82
    v_perm_b32 v55, v190, v186, s83
    v_perm_b32 v59, v191, v187, s82
    v_perm_b32 v63, v191, v187, s83
    s_waitcnt lgkmcnt(0)
    s_barrier
    ds_read_b64 v[128:129], v87 offset:6144
    s_waitcnt lgkmcnt(0)
    v_add_f32 v128, v128, v129
    s_nop 1
    v_add_f32_dpp v128, v128, v128 row_ror:8 row_mask:0xf bank_mask:0xf
    s_nop 1
    v_mov_b32_dpp v129, v128 quad_perm:[1,1,3,3] row_mask:0xf bank_mask:0xf
    v_cvt_pk_bf16_f32 v128, v128, v129
    s_nop 1
    v_mov_b32_dpp v8, v128 row_newbcast:0 row_mask:0xf bank_mask:0xf
    v_mov_b32_dpp v9, v128 row_newbcast:2 row_mask:0xf bank_mask:0xf
    v_mov_b32_dpp v10, v128 row_newbcast:4 row_mask:0xf bank_mask:0xf
    v_mov_b32_dpp v11, v128 row_newbcast:6 row_mask:0xf bank_mask:0xf
    s_nop 1
    v_mfma_f32_16x16x32_bf16 v[96:99], v[8:11], v[32:35], 0
    v_mfma_f32_16x16x32_bf16 v[100:103], v[8:11], v[36:39], 0
    v_mfma_f32_16x16x32_bf16 v[104:107], v[8:11], v[40:43], 0
    v_mfma_f32_16x16x32_bf16 v[108:111], v[8:11], v[44:47], 0
    v_mfma_f32_16x16x32_bf16 v[112:115], v[8:11], v[48:51], 0
    v_mfma_f32_16x16x32_bf16 v[116:119], v[8:11], v[52:55], 0
    v_mfma_f32_16x16x32_bf16 v[120:123], v[8:11], v[56:59], 0
    v_mfma_f32_16x16x32_bf16 v[124:127], v[8:11], v[60:63], 0
    s_mov_b64 exec, 0xffff
    v_and_or_b32 v252, v96, s6, v5
    v_and_or_b32 v253, v100, s6, v5
    v_and_or_b32 v254, v104, s6, v5
    v_and_or_b32 v255, v108, s6, v5
    s_mov_b32 exec_lo, s86
    v_and_or_b32 v252, v112, s6, v5
    v_and_or_b32 v253, v116, s6, v5
    v_and_or_b32 v254, v120, s6, v5
    v_and_or_b32 v255, v124, s6, v5
    s_mov_b32 exec_lo, -1
    buffer_store_dwordx4 v[252:255], v93, s[56:59], 0 offen sc1
    s_mov_b64 exec, -1
L_final:
    s_cmp_lt_u32 s2, 192
    s_cbranch_scc1 L_fin
    buffer_load_dwordx4 v[192:195], v95, s[56:59], s15 offen sc1
    buffer_load_dwordx4 v[196:199], v94, s[56:59], s16 offen sc1
    buffer_load_dwordx4 v[200:203], v94, s[56:59], s17 offen sc1
    v_lshlrev_b32 v26, 16, v26
    s_lshl_b32 s76, s3, 2
    s_add_u32 s76, s76, 6656
    v_and_b32 v212, 3, v1
    v_lshl_add_u32 v212, v212, 2, v31
    v_lshl_add_u32 v212, v212, 4, s76
    v_and_b32 v213, 15, v1
    v_lshlrev_b32 v214, 4, v213
    v_lshlrev_b32 v213, 1, v213
    s_waitcnt vmcnt(0)
    v_xor_b32 v192, v5, v192
    v_xor_b32 v193, v5, v193
    v_xor_b32 v194, v5, v194
    v_xor_b32 v195, v5, v195
    v_xor_b32 v196, v5, v196
    v_xor_b32 v197, v5, v197
    v_xor_b32 v198, v5, v198
    v_xor_b32 v199, v5, v199
    v_xor_b32 v200, v5, v200
    v_xor_b32 v201, v5, v201
    v_xor_b32 v202, v5, v202
    v_xor_b32 v203, v5, v203
    v_or3_b32 v27, v192, v193, v194
    v_or3_b32 v27, v27, v195, v196
    v_or3_b32 v27, v27, v197, v198
    v_or3_b32 v27, v27, v199, v200
    v_or3_b32 v27, v27, v201, v202
    v_or_b32 v27, v27, v203
    v_and_b32 v27, 0xff, v27
    v_cmp_ne_u32 vcc, 0, v27
    s_cbranch_vccnz L_fin_retry_19
L_fin_ok_20:
    v_add_f32 v196, v196, v200
    v_add_f32 v197, v197, v201
    v_add_f32 v198, v198, v202
    v_add_f32 v199, v199, v203
    v_permlane32_swap_b32 v192, v194
    v_permlane32_swap_b32 v193, v195
    v_permlane32_swap_b32 v196, v198
    v_permlane32_swap_b32 v197, v199
    v_add_f32 v192, v192, v194
    v_add_f32 v193, v193, v195
    v_add_f32 v196, v196, v198
    v_add_f32 v197, v197, v199
    v_permlane16_swap_b32 v192, v193
    s_nop 0
    v_permlane16_swap_b32 v196, v197
    v_add_f32 v192, v192, v193
    v_add_f32 v196, v196, v197
    s_nop 0
    v_add_f32_dpp v192, v192, v192 row_ror:8 row_mask:0xf bank_mask:0xf
    v_add_f32_dpp v196, v196, v196 row_ror:8 row_mask:0xf bank_mask:0xf
    s_nop 0
    v_add_f32_dpp v192, v192, v192 row_ror:4 row_mask:0xf bank_mask:0xf
    v_add_f32_dpp v196, v196, v196 row_ror:4 row_mask:0xf bank_mask:0xf
    ds_write_b32 v212, v192
    ds_write_b32 v212, v196 offset:512
    s_waitcnt lgkmcnt(0)
    s_barrier
    s_cmp_lg_u32 s3, 0
    s_cbranch_scc1 L_ep
    ds_read_b128 v[192:195], v214 offset:6656
    ds_read_b128 v[200:203], v214 offset:7168
    s_waitcnt lgkmcnt(1)
    v_add_f32 v192, v192, v193
    v_add_f32 v194, v194, v195
    v_add_f32 v192, v192, v194
    v_mul_f32 v192, 0.5, v192
    v_cvt_pk_bf16_f32 v192, v192, v192
    v_lshlrev_b32 v192, 16, v192
    v_mul_f32 v193, s91, v192
    v_exp_f32 v193, -v193
    s_nop 0
    v_add_f32 v193, 1.0, v193
    v_rcp_f32 v193, v193
    s_nop 0
    v_mul_f32 v192, v192, v193
    v_cvt_pk_bf16_f32 v192, v192, v192
    v_lshlrev_b32 v192, 16, v192
    s_waitcnt lgkmcnt(0)
    v_add_f32 v200, v200, v201
    v_add_f32 v202, v202, v203
    v_add_f32 v200, v200, v202
    v_cvt_pk_bf16_f32 v200, v200, v200
    v_lshlrev_b32 v200, 16, v200
    v_mul_f32 v192, v192, v200
    v_cvt_pk_bf16_f32 v192, v192, v192
    v_lshlrev_b32 v192, 16, v192
    v_add_f32 v192, v192, v26
    v_cvt_pk_bf16_f32 v192, v192, v192
    s_mov_b32 exec_hi, 0
    s_mov_b32 exec_lo, 65535
    buffer_store_short v192, v213, s[64:67], s20 offen
L_fin:
L_end:
    s_endpgm
L_ep:
    s_lshl_b32 s76, s90, 2
    s_add_u32 s76, s76, s3
    s_cmp_lg_u32 s76, 1
    s_cbranch_scc1 L_fin
    v_mov_b32 v27, s4
    v_mov_b32 v28, 492032
    s_mov_b64 exec, 1
    buffer_store_dword v27, v28, s[56:59], 0 offen sc1
    s_branch L_fin
L_role1:
    s_add_u32 s73, s80, 0
    s_waitcnt vmcnt(5)
    buffer_load_dwordx4 v[128:131], v6, s[52:55], s73 offen nt
    v_perm_b32 v32, v228, v224, s82
    v_perm_b32 v36, v228, v224, s83
    v_perm_b32 v40, v229, v225, s82
    v_perm_b32 v44, v229, v225, s83
    v_perm_b32 v48, v230, v226, s82
    v_perm_b32 v52, v230, v226, s83
    v_perm_b32 v56, v231, v227, s82
    v_perm_b32 v60, v231, v227, s83
    s_waitcnt vmcnt(5)
    buffer_load_dwordx4 v[132:135], v6, s[52:55], s73 offen offset:2048 nt
    v_perm_b32 v33, v236, v232, s82
    v_perm_b32 v37, v236, v232, s83
    v_perm_b32 v41, v237, v233, s82
    v_perm_b32 v45, v237, v233, s83
    v_perm_b32 v49, v238, v234, s82
    v_perm_b32 v53, v238, v234, s83
    v_perm_b32 v57, v239, v235, s82
    v_perm_b32 v61, v239, v235, s83
    s_add_u32 s73, s80, 4096
    s_waitcnt vmcnt(5)
    buffer_load_dwordx4 v[136:139], v6, s[52:55], s73 offen nt
    s_waitcnt vmcnt(5)
    v_perm_b32 v34, v244, v240, s82
    v_perm_b32 v38, v244, v240, s83
    v_perm_b32 v42, v245, v241, s82
    v_perm_b32 v46, v245, v241, s83
    v_perm_b32 v50, v246, v242, s82
    v_perm_b32 v54, v246, v242, s83
    v_perm_b32 v58, v247, v243, s82
    v_perm_b32 v62, v247, v243, s83
    s_waitcnt vmcnt(3)
    v_perm_b32 v35, v252, v248, s82
    v_perm_b32 v39, v252, v248, s83
    s_nop 0
    v_mfma_f32_16x16x32_bf16 a[0:3], v[120:123], v[32:35], a[0:3]
    v_perm_b32 v43, v253, v249, s82
    v_mfma_f32_16x16x32_bf16 a[4:7], v[120:123], v[36:39], a[4:7]
    v_perm_b32 v47, v253, v249, s83
    v_mfma_f32_16x16x32_bf16 a[8:11], v[120:123], v[40:43], a[8:11]
    v_perm_b32 v51, v254, v250, s82
    v_mfma_f32_16x16x32_bf16 a[12:15], v[120:123], v[44:47], a[12:15]
    v_perm_b32 v55, v254, v250, s83
    v_mfma_f32_16x16x32_bf16 a[16:19], v[120:123], v[48:51], a[16:19]
    v_perm_b32 v59, v255, v251, s82
    v_mfma_f32_16x16x32_bf16 a[20:23], v[120:123], v[52:55], a[20:23]
    v_perm_b32 v63, v255, v251, s83
    v_mfma_f32_16x16x32_bf16 a[24:27], v[120:123], v[56:59], a[24:27]
    s_nop 0
    v_mfma_f32_16x16x32_bf16 a[28:31], v[120:123], v[60:63], a[28:31]
    s_lshl_b32 s76, s3, 12
    s_add_u32 s76, s76, 8192
    v_add_u32 v27, s76, v2
    s_mov_b32 exec_hi, 0
    ds_write_b128 v27, a[0:3] offset:0
    ds_write_b128 v27, a[4:7] offset:512
    ds_write_b128 v27, a[8:11] offset:1024
    ds_write_b128 v27, a[12:15] offset:1536
    ds_write_b128 v27, a[16:19] offset:2048
    ds_write_b128 v27, a[20:23] offset:2560
    ds_write_b128 v27, a[24:27] offset:3072
    ds_write_b128 v27, a[28:31] offset:3584
    s_mov_b64 exec, -1
    s_lshl_b32 s76, s3, 10
    s_add_u32 s77, s76, 8192
    v_add_u32 v27, s77, v2
    v_and_b32 v28, 16, v1
    s_waitcnt lgkmcnt(0)
    s_barrier
    ds_read_b128 v[32:35], v27 offset:0
    ds_read_b128 v[48:51], v28 offset:5632
    ds_read_b128 v[36:39], v27 offset:4096
    ds_read_b128 v[52:55], v28 offset:5696
    ds_read_b128 v[40:43], v27 offset:8192
    ds_read_b128 v[56:59], v28 offset:5760
    ds_read_b128 v[44:47], v27 offset:12288
    ds_read_b128 v[60:63], v28 offset:5824
    s_waitcnt lgkmcnt(6)
    v_mul_f32 v32, v32, v48
    v_mul_f32 v33, v33, v49
    v_mul_f32 v34, v34, v50
    v_mul_f32 v35, v35, v51
    s_waitcnt lgkmcnt(4)
    v_fmac_f32 v32, v36, v52
    v_fmac_f32 v33, v37, v53
    v_fmac_f32 v34, v38, v54
    v_fmac_f32 v35, v39, v55
    s_waitcnt lgkmcnt(2)
    v_fmac_f32 v32, v40, v56
    v_fmac_f32 v33, v41, v57
    v_fmac_f32 v34, v42, v58
    v_fmac_f32 v35, v43, v59
    s_waitcnt lgkmcnt(0)
    v_fmac_f32 v32, v44, v60
    v_fmac_f32 v33, v45, v61
    v_fmac_f32 v34, v46, v62
    v_fmac_f32 v35, v47, v63
    v_and_or_b32 v32, v32, s6, v5
    v_and_or_b32 v33, v33, s6, v5
    v_and_or_b32 v34, v34, s6, v5
    v_and_or_b32 v35, v35, s6, v5
    buffer_store_dwordx4 v[32:35], v2, s[56:59], s11 offen sc1
    buffer_load_dwordx4 v[140:143], v6, s[52:55], s73 offen offset:2048 nt
    s_add_u32 s73, s80, 8192
    buffer_load_dwordx4 v[144:147], v6, s[52:55], s73 offen nt
    buffer_load_dwordx4 v[148:151], v6, s[52:55], s73 offen offset:2048 nt
    s_add_u32 s73, s80, 12288
    buffer_load_dwordx4 v[152:155], v6, s[52:55], s73 offen nt
    s_add_u32 s73, s81, 0
    buffer_load_dwordx4 v[160:163], v7, s[40:43], s73 offen nt
    s_add_u32 s73, s81, 262144
    buffer_load_dwordx4 v[164:167], v7, s[40:43], s73 offen nt
    s_add_u32 s73, s81, 524288
    buffer_load_dwordx4 v[168:171], v7, s[40:43], s73 offen nt
    s_add_u32 s73, s81, 786432
    buffer_load_dwordx4 v[172:175], v7, s[40:43], s73 offen nt
    s_add_u32 s73, s81, 16384
    buffer_load_dwordx4 v[176:179], v7, s[40:43], s73 offen nt
    s_add_u32 s73, s81, 278528
    buffer_load_dwordx4 v[180:183], v7, s[40:43], s73 offen nt
    s_add_u32 s73, s81, 540672
    buffer_load_dwordx4 v[184:187], v7, s[40:43], s73 offen nt
    s_add_u32 s73, s81, 802816
    buffer_load_dwordx4 v[188:191], v7, s[40:43], s73 offen nt
    s_lshl_b32 s76, s3, 9
    s_add_u32 s76, s76, 24576
    v_lshl_add_u32 v27, v30, 5, s76
    v_lshl_add_u32 v27, v31, 4, v27
    s_waitcnt vmcnt(8)
    v_perm_b32 v32, v132, v128, s82
    v_perm_b32 v33, v140, v136, s82
    v_perm_b32 v34, v148, v144, s82
    v_perm_b32 v35, v152, v152, s84
    v_perm_b32 v36, v132, v128, s83
    v_perm_b32 v37, v140, v136, s83
    v_perm_b32 v38, v148, v144, s83
    v_perm_b32 v39, v152, v152, s85
    v_mfma_f32_16x16x32_bf16 v[96:99], v[12:15], v[32:35], 0
    v_perm_b32 v40, v133, v129, s82
    v_perm_b32 v41, v141, v137, s82
    v_perm_b32 v42, v149, v145, s82
    v_perm_b32 v43, v153, v153, s84
    v_mfma_f32_16x16x32_bf16 v[100:103], v[12:15], v[36:39], 0
    v_perm_b32 v44, v133, v129, s83
    v_perm_b32 v45, v141, v137, s83
    v_perm_b32 v46, v149, v145, s83
    v_perm_b32 v47, v153, v153, s85
    v_mfma_f32_16x16x32_bf16 v[104:107], v[12:15], v[40:43], 0
    v_perm_b32 v48, v134, v130, s82
    v_perm_b32 v49, v142, v138, s82
    v_perm_b32 v50, v150, v146, s82
    v_perm_b32 v51, v154, v154, s84
    v_mfma_f32_16x16x32_bf16 v[108:111], v[12:15], v[44:47], 0
    v_perm_b32 v52, v134, v130, s83
    v_perm_b32 v53, v142, v138, s83
    v_perm_b32 v54, v150, v146, s83
    v_perm_b32 v55, v154, v154, s85
    v_mfma_f32_16x16x32_bf16 v[112:115], v[12:15], v[48:51], 0
    v_perm_b32 v56, v135, v131, s82
    v_perm_b32 v57, v143, v139, s82
    v_perm_b32 v58, v151, v147, s82
    v_perm_b32 v59, v155, v155, s84
    v_mfma_f32_16x16x32_bf16 v[116:119], v[12:15], v[52:55], 0
    v_perm_b32 v60, v135, v131, s83
    v_perm_b32 v61, v143, v139, s83
    v_perm_b32 v62, v151, v147, s83
    v_perm_b32 v63, v155, v155, s85
    v_mfma_f32_16x16x32_bf16 v[120:123], v[12:15], v[56:59], 0
    s_nop 0
    v_mfma_f32_16x16x32_bf16 v[124:127], v[12:15], v[60:63], 0
    s_mov_b64 exec, 0xffff
    v_mov_b32 v252, v96
    v_mov_b32 v253, v100
    v_mov_b32 v254, v104
    v_mov_b32 v255, v108
    s_mov_b32 exec_lo, s86
    v_mov_b32 v252, v112
    v_mov_b32 v253, v116
    v_mov_b32 v254, v120
    v_mov_b32 v255, v124
    s_mov_b32 exec_lo, -1
    ds_write_b128 v27, v[252:255]
    s_mov_b64 exec, -1
    s_waitcnt vmcnt(6)
    buffer_load_dwordx4 v[240:243], v92, s[56:59], s12 offen sc1
    buffer_load_dwordx4 v[244:247], v92, s[56:59], s13 offen sc1
    v_perm_b32 v32, v164, v160, s82
    v_perm_b32 v36, v164, v160, s83
    v_perm_b32 v40, v165, v161, s82
    v_perm_b32 v44, v165, v161, s83
    v_perm_b32 v48, v166, v162, s82
    v_perm_b32 v52, v166, v162, s83
    v_perm_b32 v56, v167, v163, s82
    v_perm_b32 v60, v167, v163, s83
    s_waitcnt vmcnt(6)
    v_perm_b32 v33, v172, v168, s82
    v_perm_b32 v37, v172, v168, s83
    v_perm_b32 v41, v173, v169, s82
    v_perm_b32 v45, v173, v169, s83
    v_perm_b32 v49, v174, v170, s82
    v_perm_b32 v53, v174, v170, s83
    v_perm_b32 v57, v175, v171, s82
    v_perm_b32 v61, v175, v171, s83
    s_waitcnt vmcnt(4)
    v_perm_b32 v34, v180, v176, s82
    v_perm_b32 v38, v180, v176, s83
    v_perm_b32 v42, v181, v177, s82
    v_perm_b32 v46, v181, v177, s83
    v_perm_b32 v50, v182, v178, s82
    v_perm_b32 v54, v182, v178, s83
    v_perm_b32 v58, v183, v179, s82
    v_perm_b32 v62, v183, v179, s83
    s_waitcnt vmcnt(0)
    v_xor_b32 v240, v5, v240
    v_xor_b32 v241, v5, v241
    v_xor_b32 v242, v5, v242
    v_xor_b32 v243, v5, v243
    v_xor_b32 v244, v5, v244
    v_xor_b32 v245, v5, v245
    v_xor_b32 v246, v5, v246
    v_xor_b32 v247, v5, v247
    v_or3_b32 v27, v240, v241, v242
    v_or3_b32 v27, v27, v243, v244
    v_or3_b32 v27, v27, v245, v246
    v_or_b32 v27, v27, v247
    v_and_b32 v27, 0xff, v27
    v_cmp_ne_u32 vcc, 0, v27
    s_cbranch_vccnz L_og_retry_21
L_og_ok_22:
    v_add_f32 v240, v240, v244
    v_add_f32 v241, v241, v245
    v_add_f32 v242, v242, v246
    v_add_f32 v243, v243, v247
    s_nop 0
    v_permlane32_swap_b32 v240, v242
    v_permlane32_swap_b32 v241, v243
    v_add_f32 v240, v240, v242
    v_add_f32 v241, v241, v243
    s_nop 1
    v_permlane16_swap_b32 v240, v241
    v_add_f32 v240, v240, v241
    s_nop 1
    v_add_f32_dpp v240, v240, v240 row_ror:8 row_mask:0xf bank_mask:0xf
    ds_write_b32 v86, v240
    v_perm_b32 v35, v188, v184, s82
    v_perm_b32 v39, v188, v184, s83
    v_perm_b32 v43, v189, v185, s82
    v_perm_b32 v47, v189, v185, s83
    v_perm_b32 v51, v190, v186, s82
    v_perm_b32 v55, v190, v186, s83
    v_perm_b32 v59, v191, v187, s82
    v_perm_b32 v63, v191, v187, s83
    s_waitcnt lgkmcnt(0)
    s_barrier
    ds_read_b64 v[128:129], v87 offset:6144
    ds_read_b128 v[224:227], v76 offset:24576
    ds_read_b128 v[228:231], v76 offset:25088
    ds_read_b128 v[232:235], v76 offset:25600
    ds_read_b128 v[236:239], v76 offset:26112
    s_waitcnt lgkmcnt(4)
    v_add_f32 v128, v128, v129
    s_nop 1
    v_add_f32_dpp v128, v128, v128 row_ror:8 row_mask:0xf bank_mask:0xf
    s_nop 1
    v_mov_b32_dpp v129, v128 quad_perm:[1,1,3,3] row_mask:0xf bank_mask:0xf
    v_cvt_pk_bf16_f32 v128, v128, v129
    s_nop 1
    v_mov_b32_dpp v8, v128 row_newbcast:0 row_mask:0xf bank_mask:0xf
    v_mov_b32_dpp v9, v128 row_newbcast:2 row_mask:0xf bank_mask:0xf
    v_mov_b32_dpp v10, v128 row_newbcast:4 row_mask:0xf bank_mask:0xf
    v_mov_b32_dpp v11, v128 row_newbcast:6 row_mask:0xf bank_mask:0xf
    s_nop 1
    v_mfma_f32_16x16x32_bf16 v[96:99], v[8:11], v[32:35], 0
    v_mfma_f32_16x16x32_bf16 v[100:103], v[8:11], v[36:39], 0
    v_mfma_f32_16x16x32_bf16 v[104:107], v[8:11], v[40:43], 0
    v_mfma_f32_16x16x32_bf16 v[108:111], v[8:11], v[44:47], 0
    v_mfma_f32_16x16x32_bf16 v[112:115], v[8:11], v[48:51], 0
    v_mfma_f32_16x16x32_bf16 v[116:119], v[8:11], v[52:55], 0
    v_mfma_f32_16x16x32_bf16 v[120:123], v[8:11], v[56:59], 0
    v_mfma_f32_16x16x32_bf16 v[124:127], v[8:11], v[60:63], 0
    s_waitcnt lgkmcnt(0)
    v_add_f32 v224, v224, v228
    v_add_f32 v232, v232, v236
    v_add_f32 v225, v225, v229
    v_add_f32 v233, v233, v237
    v_add_f32 v226, v226, v230
    v_add_f32 v234, v234, v238
    v_add_f32 v227, v227, v231
    v_add_f32 v235, v235, v239
    v_add_f32 v224, v224, v232
    v_add_f32 v225, v225, v233
    v_add_f32 v226, v226, v234
    v_add_f32 v227, v227, v235
    v_and_or_b32 v252, v224, s6, v5
    v_and_or_b32 v253, v225, s6, v5
    v_and_or_b32 v254, v226, s6, v5
    v_and_or_b32 v255, v227, s6, v5
    s_mov_b64 exec, 0xffff
    v_and_or_b32 v252, v96, s6, v5
    v_and_or_b32 v253, v100, s6, v5
    v_and_or_b32 v254, v104, s6, v5
    v_and_or_b32 v255, v108, s6, v5
    s_mov_b32 exec_lo, s86
    v_and_or_b32 v252, v112, s6, v5
    v_and_or_b32 v253, v116, s6, v5
    v_and_or_b32 v254, v120, s6, v5
    v_and_or_b32 v255, v124, s6, v5
    s_mov_b32 exec_lo, -1
    s_mov_b32 exec_hi, 255
    buffer_store_dwordx4 v[252:255], v93, s[56:59], 0 offen sc1
    s_mov_b64 exec, -1
    s_branch L_final
L_role2:
    s_add_u32 s73, s80, 0
    s_waitcnt vmcnt(5)
    buffer_load_dwordx4 v[128:131], v6, s[52:55], s73 offen nt
    v_perm_b32 v32, v228, v224, s82
    v_perm_b32 v36, v228, v224, s83
    v_perm_b32 v40, v229, v225, s82
    v_perm_b32 v44, v229, v225, s83
    v_perm_b32 v48, v230, v226, s82
    v_perm_b32 v52, v230, v226, s83
    v_perm_b32 v56, v231, v227, s82
    v_perm_b32 v60, v231, v227, s83
    s_waitcnt vmcnt(5)
    buffer_load_dwordx4 v[132:135], v6, s[52:55], s73 offen offset:2048 nt
    v_perm_b32 v33, v236, v232, s82
    v_perm_b32 v37, v236, v232, s83
    v_perm_b32 v41, v237, v233, s82
    v_perm_b32 v45, v237, v233, s83
    v_perm_b32 v49, v238, v234, s82
    v_perm_b32 v53, v238, v234, s83
    v_perm_b32 v57, v239, v235, s82
    v_perm_b32 v61, v239, v235, s83
    s_add_u32 s73, s80, 4096
    s_waitcnt vmcnt(5)
    buffer_load_dwordx4 v[136:139], v6, s[52:55], s73 offen nt
    s_waitcnt vmcnt(5)
    v_perm_b32 v34, v244, v240, s82
    v_perm_b32 v38, v244, v240, s83
    v_perm_b32 v42, v245, v241, s82
    v_perm_b32 v46, v245, v241, s83
    v_perm_b32 v50, v246, v242, s82
    v_perm_b32 v54, v246, v242, s83
    v_perm_b32 v58, v247, v243, s82
    v_perm_b32 v62, v247, v243, s83
    s_waitcnt vmcnt(3)
    v_perm_b32 v35, v252, v248, s82
    v_perm_b32 v39, v252, v248, s83
    s_nop 0
    v_mfma_f32_16x16x32_bf16 a[0:3], v[120:123], v[32:35], a[0:3]
    v_perm_b32 v43, v253, v249, s82
    v_mfma_f32_16x16x32_bf16 a[4:7], v[120:123], v[36:39], a[4:7]
    v_perm_b32 v47, v253, v249, s83
    v_mfma_f32_16x16x32_bf16 a[8:11], v[120:123], v[40:43], a[8:11]
    v_perm_b32 v51, v254, v250, s82
    v_mfma_f32_16x16x32_bf16 a[12:15], v[120:123], v[44:47], a[12:15]
    v_perm_b32 v55, v254, v250, s83
    v_mfma_f32_16x16x32_bf16 a[16:19], v[120:123], v[48:51], a[16:19]
    v_perm_b32 v59, v255, v251, s82
    v_mfma_f32_16x16x32_bf16 a[20:23], v[120:123], v[52:55], a[20:23]
    v_perm_b32 v63, v255, v251, s83
    v_mfma_f32_16x16x32_bf16 a[24:27], v[120:123], v[56:59], a[24:27]
    s_nop 0
    v_mfma_f32_16x16x32_bf16 a[28:31], v[120:123], v[60:63], a[28:31]
    s_lshl_b32 s76, s3, 12
    s_add_u32 s76, s76, 8192
    v_add_u32 v27, s76, v2
    s_mov_b32 exec_hi, 0
    ds_write_b128 v27, a[0:3] offset:0
    ds_write_b128 v27, a[4:7] offset:512
    ds_write_b128 v27, a[8:11] offset:1024
    ds_write_b128 v27, a[12:15] offset:1536
    ds_write_b128 v27, a[16:19] offset:2048
    ds_write_b128 v27, a[20:23] offset:2560
    ds_write_b128 v27, a[24:27] offset:3072
    ds_write_b128 v27, a[28:31] offset:3584
    s_mov_b64 exec, -1
    s_lshl_b32 s76, s3, 10
    s_add_u32 s77, s76, 8192
    v_add_u32 v27, s77, v2
    v_and_b32 v28, 16, v1
    s_waitcnt lgkmcnt(0)
    s_barrier
    ds_read_b128 v[32:35], v27 offset:0
    ds_read_b128 v[48:51], v28 offset:5632
    ds_read_b128 v[36:39], v27 offset:4096
    ds_read_b128 v[52:55], v28 offset:5696
    ds_read_b128 v[40:43], v27 offset:8192
    ds_read_b128 v[56:59], v28 offset:5760
    ds_read_b128 v[44:47], v27 offset:12288
    ds_read_b128 v[60:63], v28 offset:5824
    s_waitcnt lgkmcnt(6)
    v_mul_f32 v32, v32, v48
    v_mul_f32 v33, v33, v49
    v_mul_f32 v34, v34, v50
    v_mul_f32 v35, v35, v51
    s_waitcnt lgkmcnt(4)
    v_fmac_f32 v32, v36, v52
    v_fmac_f32 v33, v37, v53
    v_fmac_f32 v34, v38, v54
    v_fmac_f32 v35, v39, v55
    s_waitcnt lgkmcnt(2)
    v_fmac_f32 v32, v40, v56
    v_fmac_f32 v33, v41, v57
    v_fmac_f32 v34, v42, v58
    v_fmac_f32 v35, v43, v59
    s_waitcnt lgkmcnt(0)
    v_fmac_f32 v32, v44, v60
    v_fmac_f32 v33, v45, v61
    v_fmac_f32 v34, v46, v62
    v_fmac_f32 v35, v47, v63
    v_and_or_b32 v32, v32, s6, v5
    v_and_or_b32 v33, v33, s6, v5
    v_and_or_b32 v34, v34, s6, v5
    v_and_or_b32 v35, v35, s6, v5
    buffer_store_dwordx4 v[32:35], v2, s[56:59], s11 offen sc1
    buffer_load_dwordx4 v[140:143], v6, s[52:55], s73 offen offset:2048 nt
    s_add_u32 s73, s80, 8192
    buffer_load_dwordx4 v[144:147], v6, s[52:55], s73 offen nt
    buffer_load_dwordx4 v[148:151], v6, s[52:55], s73 offen offset:2048 nt
    s_add_u32 s73, s80, 12288
    buffer_load_dwordx4 v[152:155], v6, s[52:55], s73 offen nt
    s_add_u32 s73, s27, 0
    buffer_load_dwordx4 v[192:195], v6, s[52:55], s73 offen nt
    buffer_load_dwordx4 v[196:199], v6, s[52:55], s73 offen offset:2048 nt
    s_add_u32 s73, s27, 4096
    buffer_load_dwordx4 v[200:203], v6, s[52:55], s73 offen nt
    buffer_load_dwordx4 v[204:207], v6, s[52:55], s73 offen offset:2048 nt
    s_add_u32 s73, s27, 8192
    buffer_load_dwordx4 v[208:211], v6, s[52:55], s73 offen nt
    buffer_load_dwordx4 v[212:215], v6, s[52:55], s73 offen offset:2048 nt
    s_add_u32 s73, s27, 12288
    buffer_load_dwordx4 v[216:219], v6, s[52:55], s73 offen nt
    s_add_u32 s73, s81, 0
    buffer_load_dwordx4 v[160:163], v7, s[40:43], s73 offen nt
    s_add_u32 s73, s81, 262144
    buffer_load_dwordx4 v[164:167], v7, s[40:43], s73 offen nt
    s_add_u32 s73, s81, 524288
    buffer_load_dwordx4 v[168:171], v7, s[40:43], s73 offen nt
    s_add_u32 s73, s81, 786432
    buffer_load_dwordx4 v[172:175], v7, s[40:43], s73 offen nt
    s_add_u32 s73, s81, 16384
    buffer_load_dwordx4 v[176:179], v7, s[40:43], s73 offen nt
    s_add_u32 s73, s81, 278528
    buffer_load_dwordx4 v[180:183], v7, s[40:43], s73 offen nt
    s_add_u32 s73, s81, 540672
    buffer_load_dwordx4 v[184:187], v7, s[40:43], s73 offen nt
    s_add_u32 s73, s81, 802816
    buffer_load_dwordx4 v[188:191], v7, s[40:43], s73 offen nt
    s_lshl_b32 s76, s3, 9
    s_add_u32 s76, s76, 24576
    v_lshl_add_u32 v27, v30, 5, s76
    v_lshl_add_u32 v27, v31, 4, v27
    s_waitcnt vmcnt(15)
    v_perm_b32 v32, v132, v128, s82
    v_perm_b32 v33, v140, v136, s82
    v_perm_b32 v34, v148, v144, s82
    v_perm_b32 v35, v152, v152, s84
    v_perm_b32 v36, v132, v128, s83
    v_perm_b32 v37, v140, v136, s83
    v_perm_b32 v38, v148, v144, s83
    v_perm_b32 v39, v152, v152, s85
    v_mfma_f32_16x16x32_bf16 v[96:99], v[12:15], v[32:35], 0
    v_perm_b32 v40, v133, v129, s82
    v_perm_b32 v41, v141, v137, s82
    v_perm_b32 v42, v149, v145, s82
    v_perm_b32 v43, v153, v153, s84
    v_mfma_f32_16x16x32_bf16 v[100:103], v[12:15], v[36:39], 0
    v_perm_b32 v44, v133, v129, s83
    v_perm_b32 v45, v141, v137, s83
    v_perm_b32 v46, v149, v145, s83
    v_perm_b32 v47, v153, v153, s85
    v_mfma_f32_16x16x32_bf16 v[104:107], v[12:15], v[40:43], 0
    v_perm_b32 v48, v134, v130, s82
    v_perm_b32 v49, v142, v138, s82
    v_perm_b32 v50, v150, v146, s82
    v_perm_b32 v51, v154, v154, s84
    v_mfma_f32_16x16x32_bf16 v[108:111], v[12:15], v[44:47], 0
    v_perm_b32 v52, v134, v130, s83
    v_perm_b32 v53, v142, v138, s83
    v_perm_b32 v54, v150, v146, s83
    v_perm_b32 v55, v154, v154, s85
    v_mfma_f32_16x16x32_bf16 v[112:115], v[12:15], v[48:51], 0
    v_perm_b32 v56, v135, v131, s82
    v_perm_b32 v57, v143, v139, s82
    v_perm_b32 v58, v151, v147, s82
    v_perm_b32 v59, v155, v155, s84
    v_mfma_f32_16x16x32_bf16 v[116:119], v[12:15], v[52:55], 0
    v_perm_b32 v60, v135, v131, s83
    v_perm_b32 v61, v143, v139, s83
    v_perm_b32 v62, v151, v147, s83
    v_perm_b32 v63, v155, v155, s85
    v_mfma_f32_16x16x32_bf16 v[120:123], v[12:15], v[56:59], 0
    s_nop 0
    v_mfma_f32_16x16x32_bf16 v[124:127], v[12:15], v[60:63], 0
    s_mov_b64 exec, 0xffff
    v_mov_b32 v252, v96
    v_mov_b32 v253, v100
    v_mov_b32 v254, v104
    v_mov_b32 v255, v108
    s_mov_b32 exec_lo, s86
    v_mov_b32 v252, v112
    v_mov_b32 v253, v116
    v_mov_b32 v254, v120
    v_mov_b32 v255, v124
    s_mov_b32 exec_lo, -1
    ds_write_b128 v27, v[252:255]
    s_mov_b64 exec, -1
    s_lshl_b32 s76, s3, 9
    s_add_u32 s76, s76, 26624
    v_lshl_add_u32 v27, v30, 5, s76
    v_lshl_add_u32 v27, v31, 4, v27
    s_waitcnt vmcnt(8)
    v_perm_b32 v32, v196, v192, s82
    v_perm_b32 v33, v204, v200, s82
    v_perm_b32 v34, v212, v208, s82
    v_perm_b32 v35, v216, v216, s84
    v_perm_b32 v36, v196, v192, s83
    v_perm_b32 v37, v204, v200, s83
    v_perm_b32 v38, v212, v208, s83
    v_perm_b32 v39, v216, v216, s85
    v_mfma_f32_16x16x32_bf16 v[96:99], v[16:19], v[32:35], 0
    v_perm_b32 v40, v197, v193, s82
    v_perm_b32 v41, v205, v201, s82
    v_perm_b32 v42, v213, v209, s82
    v_perm_b32 v43, v217, v217, s84
    v_mfma_f32_16x16x32_bf16 v[100:103], v[16:19], v[36:39], 0
    v_perm_b32 v44, v197, v193, s83
    v_perm_b32 v45, v205, v201, s83
    v_perm_b32 v46, v213, v209, s83
    v_perm_b32 v47, v217, v217, s85
    v_mfma_f32_16x16x32_bf16 v[104:107], v[16:19], v[40:43], 0
    v_perm_b32 v48, v198, v194, s82
    v_perm_b32 v49, v206, v202, s82
    v_perm_b32 v50, v214, v210, s82
    v_perm_b32 v51, v218, v218, s84
    v_mfma_f32_16x16x32_bf16 v[108:111], v[16:19], v[44:47], 0
    v_perm_b32 v52, v198, v194, s83
    v_perm_b32 v53, v206, v202, s83
    v_perm_b32 v54, v214, v210, s83
    v_perm_b32 v55, v218, v218, s85
    v_mfma_f32_16x16x32_bf16 v[112:115], v[16:19], v[48:51], 0
    v_perm_b32 v56, v199, v195, s82
    v_perm_b32 v57, v207, v203, s82
    v_perm_b32 v58, v215, v211, s82
    v_perm_b32 v59, v219, v219, s84
    v_mfma_f32_16x16x32_bf16 v[116:119], v[16:19], v[52:55], 0
    v_perm_b32 v60, v199, v195, s83
    v_perm_b32 v61, v207, v203, s83
    v_perm_b32 v62, v215, v211, s83
    v_perm_b32 v63, v219, v219, s85
    v_mfma_f32_16x16x32_bf16 v[120:123], v[16:19], v[56:59], 0
    s_nop 0
    v_mfma_f32_16x16x32_bf16 v[124:127], v[16:19], v[60:63], 0
    s_mov_b64 exec, 0xffff
    v_mov_b32 v252, v96
    v_mov_b32 v253, v100
    v_mov_b32 v254, v104
    v_mov_b32 v255, v108
    s_mov_b32 exec_lo, s86
    v_mov_b32 v252, v112
    v_mov_b32 v253, v116
    v_mov_b32 v254, v120
    v_mov_b32 v255, v124
    s_mov_b32 exec_lo, -1
    ds_write_b128 v27, v[252:255]
    s_mov_b64 exec, -1
    s_waitcnt vmcnt(6)
    buffer_load_dwordx4 v[240:243], v92, s[56:59], s12 offen sc1
    buffer_load_dwordx4 v[244:247], v92, s[56:59], s13 offen sc1
    v_perm_b32 v32, v164, v160, s82
    v_perm_b32 v36, v164, v160, s83
    v_perm_b32 v40, v165, v161, s82
    v_perm_b32 v44, v165, v161, s83
    v_perm_b32 v48, v166, v162, s82
    v_perm_b32 v52, v166, v162, s83
    v_perm_b32 v56, v167, v163, s82
    v_perm_b32 v60, v167, v163, s83
    s_waitcnt vmcnt(6)
    v_perm_b32 v33, v172, v168, s82
    v_perm_b32 v37, v172, v168, s83
    v_perm_b32 v41, v173, v169, s82
    v_perm_b32 v45, v173, v169, s83
    v_perm_b32 v49, v174, v170, s82
    v_perm_b32 v53, v174, v170, s83
    v_perm_b32 v57, v175, v171, s82
    v_perm_b32 v61, v175, v171, s83
    s_waitcnt vmcnt(4)
    v_perm_b32 v34, v180, v176, s82
    v_perm_b32 v38, v180, v176, s83
    v_perm_b32 v42, v181, v177, s82
    v_perm_b32 v46, v181, v177, s83
    v_perm_b32 v50, v182, v178, s82
    v_perm_b32 v54, v182, v178, s83
    v_perm_b32 v58, v183, v179, s82
    v_perm_b32 v62, v183, v179, s83
    s_waitcnt vmcnt(0)
    v_xor_b32 v240, v5, v240
    v_xor_b32 v241, v5, v241
    v_xor_b32 v242, v5, v242
    v_xor_b32 v243, v5, v243
    v_xor_b32 v244, v5, v244
    v_xor_b32 v245, v5, v245
    v_xor_b32 v246, v5, v246
    v_xor_b32 v247, v5, v247
    v_or3_b32 v27, v240, v241, v242
    v_or3_b32 v27, v27, v243, v244
    v_or3_b32 v27, v27, v245, v246
    v_or_b32 v27, v27, v247
    v_and_b32 v27, 0xff, v27
    v_cmp_ne_u32 vcc, 0, v27
    s_cbranch_vccnz L_og_retry_23
L_og_ok_24:
    v_add_f32 v240, v240, v244
    v_add_f32 v241, v241, v245
    v_add_f32 v242, v242, v246
    v_add_f32 v243, v243, v247
    s_nop 0
    v_permlane32_swap_b32 v240, v242
    v_permlane32_swap_b32 v241, v243
    v_add_f32 v240, v240, v242
    v_add_f32 v241, v241, v243
    s_nop 1
    v_permlane16_swap_b32 v240, v241
    v_add_f32 v240, v240, v241
    s_nop 1
    v_add_f32_dpp v240, v240, v240 row_ror:8 row_mask:0xf bank_mask:0xf
    ds_write_b32 v86, v240
    v_perm_b32 v35, v188, v184, s82
    v_perm_b32 v39, v188, v184, s83
    v_perm_b32 v43, v189, v185, s82
    v_perm_b32 v47, v189, v185, s83
    v_perm_b32 v51, v190, v186, s82
    v_perm_b32 v55, v190, v186, s83
    v_perm_b32 v59, v191, v187, s82
    v_perm_b32 v63, v191, v187, s83
    s_waitcnt lgkmcnt(0)
    s_barrier
    ds_read_b64 v[128:129], v87 offset:6144
    ds_read_b128 v[224:227], v76 offset:24576
    ds_read_b128 v[228:231], v76 offset:25088
    ds_read_b128 v[232:235], v76 offset:25600
    ds_read_b128 v[236:239], v76 offset:26112
    s_waitcnt lgkmcnt(4)
    v_add_f32 v128, v128, v129
    s_nop 1
    v_add_f32_dpp v128, v128, v128 row_ror:8 row_mask:0xf bank_mask:0xf
    s_nop 1
    v_mov_b32_dpp v129, v128 quad_perm:[1,1,3,3] row_mask:0xf bank_mask:0xf
    v_cvt_pk_bf16_f32 v128, v128, v129
    s_nop 1
    v_mov_b32_dpp v8, v128 row_newbcast:0 row_mask:0xf bank_mask:0xf
    v_mov_b32_dpp v9, v128 row_newbcast:2 row_mask:0xf bank_mask:0xf
    v_mov_b32_dpp v10, v128 row_newbcast:4 row_mask:0xf bank_mask:0xf
    v_mov_b32_dpp v11, v128 row_newbcast:6 row_mask:0xf bank_mask:0xf
    s_nop 1
    v_mfma_f32_16x16x32_bf16 v[96:99], v[8:11], v[32:35], 0
    v_mfma_f32_16x16x32_bf16 v[100:103], v[8:11], v[36:39], 0
    v_mfma_f32_16x16x32_bf16 v[104:107], v[8:11], v[40:43], 0
    v_mfma_f32_16x16x32_bf16 v[108:111], v[8:11], v[44:47], 0
    v_mfma_f32_16x16x32_bf16 v[112:115], v[8:11], v[48:51], 0
    v_mfma_f32_16x16x32_bf16 v[116:119], v[8:11], v[52:55], 0
    v_mfma_f32_16x16x32_bf16 v[120:123], v[8:11], v[56:59], 0
    v_mfma_f32_16x16x32_bf16 v[124:127], v[8:11], v[60:63], 0
    s_waitcnt lgkmcnt(0)
    v_add_f32 v224, v224, v228
    v_add_f32 v232, v232, v236
    v_add_f32 v225, v225, v229
    v_add_f32 v233, v233, v237
    v_add_f32 v226, v226, v230
    v_add_f32 v234, v234, v238
    v_add_f32 v227, v227, v231
    v_add_f32 v235, v235, v239
    v_add_f32 v224, v224, v232
    v_add_f32 v225, v225, v233
    v_add_f32 v226, v226, v234
    v_add_f32 v227, v227, v235
    v_and_or_b32 v252, v224, s6, v5
    v_and_or_b32 v253, v225, s6, v5
    v_and_or_b32 v254, v226, s6, v5
    v_and_or_b32 v255, v227, s6, v5
    s_mov_b64 exec, 0xffff
    v_and_or_b32 v252, v96, s6, v5
    v_and_or_b32 v253, v100, s6, v5
    v_and_or_b32 v254, v104, s6, v5
    v_and_or_b32 v255, v108, s6, v5
    s_mov_b32 exec_lo, s86
    v_and_or_b32 v252, v112, s6, v5
    v_and_or_b32 v253, v116, s6, v5
    v_and_or_b32 v254, v120, s6, v5
    v_and_or_b32 v255, v124, s6, v5
    s_mov_b32 exec_lo, -1
    s_mov_b32 exec_hi, 65535
    buffer_store_dwordx4 v[252:255], v93, s[56:59], 0 offen sc1
    s_mov_b64 exec, -1
    s_branch L_final
L_q_retry_4:
    s_mov_b32 s87, 4000000
L_q_retry_4_l:
    s_mov_b64 exec, vcc
    buffer_load_dwordx4 v[224:227], v248, s[56:59], s10 offen offset:512 sc1
    buffer_load_dwordx4 v[228:231], v248, s[56:59], s11 offen offset:512 sc1
    buffer_load_dwordx4 v[232:235], v248, s[56:59], s12 offen offset:512 sc1
    buffer_load_dwordx4 v[236:239], v248, s[56:59], s13 offen offset:512 sc1
    s_waitcnt vmcnt(0)
    v_xor_b32 v224, v5, v224
    v_xor_b32 v225, v5, v225
    v_xor_b32 v226, v5, v226
    v_xor_b32 v227, v5, v227
    v_xor_b32 v228, v5, v228
    v_xor_b32 v229, v5, v229
    v_xor_b32 v230, v5, v230
    v_xor_b32 v231, v5, v231
    v_xor_b32 v232, v5, v232
    v_xor_b32 v233, v5, v233
    v_xor_b32 v234, v5, v234
    v_xor_b32 v235, v5, v235
    v_xor_b32 v236, v5, v236
    v_xor_b32 v237, v5, v237
    v_xor_b32 v238, v5, v238
    v_xor_b32 v239, v5, v239
    v_or3_b32 v27, v224, v225, v226
    v_or3_b32 v27, v27, v227, v228
    v_or3_b32 v27, v27, v229, v230
    v_or3_b32 v27, v27, v231, v232
    v_or3_b32 v27, v27, v233, v234
    v_or3_b32 v27, v27, v235, v236
    v_or3_b32 v27, v27, v237, v238
    v_or_b32 v27, v27, v239
    v_and_b32 v27, 0xff, v27
    v_cmp_ne_u32 vcc, 0, v27
    s_cbranch_vccz L_q_retry_4_x
    s_sub_u32 s87, s87, 1
    s_cbranch_scc0 L_q_retry_4_l
L_q_retry_4_x:
    s_mov_b64 exec, -1
    s_nop 4
    s_branch L_q_ok_5
L_h_retry_10:
    s_mov_b32 s87, 4000000
L_h_retry_10_l:
    s_mov_b64 exec, vcc
    buffer_load_dwordx4 v[100:103], v116, s[56:59], s14 offen sc1
    s_waitcnt vmcnt(0)
    v_xor_b32 v100, v5, v100
    v_xor_b32 v101, v5, v101
    v_xor_b32 v102, v5, v102
    v_xor_b32 v103, v5, v103
    v_or3_b32 v27, v100, v101, v102
    v_or_b32 v27, v27, v103
    v_and_b32 v27, 0xff, v27
    v_cmp_ne_u32 vcc, 0, v27
    s_cbranch_vccz L_h_retry_10_x
    s_sub_u32 s87, s87, 1
    s_cbranch_scc0 L_h_retry_10_l
L_h_retry_10_x:
    s_mov_b64 exec, -1
    s_nop 4
    s_branch L_h_ok_11
L_stats_retry_12:
    s_mov_b32 s87, 4000000
L_stats_retry_12_l:
    s_mov_b64 exec, vcc
    buffer_load_dwordx4 v[68:71], v76, s[56:59], s10 offen sc1
    s_waitcnt vmcnt(0)
    v_xor_b32 v68, v5, v68
    v_xor_b32 v69, v5, v69
    v_xor_b32 v70, v5, v70
    v_xor_b32 v71, v5, v71
    v_or3_b32 v27, v68, v69, v70
    v_or_b32 v27, v27, v71
    v_and_b32 v27, 0xff, v27
    v_cmp_ne_u32 vcc, 0, v27
    s_cbranch_vccz L_stats_retry_12_x
    s_sub_u32 s87, s87, 1
    s_cbranch_scc0 L_stats_retry_12_l
L_stats_retry_12_x:
    s_mov_b64 exec, -1
    s_nop 4
    s_branch L_stats_ok_13
L_h_retry_15:
    s_mov_b32 s87, 4000000
L_h_retry_15_l:
    s_mov_b64 exec, vcc
    buffer_load_dwordx4 v[108:111], v117, s[56:59], s14 offen sc1
    s_waitcnt vmcnt(0)
    v_xor_b32 v108, v5, v108
    v_xor_b32 v109, v5, v109
    v_xor_b32 v110, v5, v110
    v_xor_b32 v111, v5, v111
    v_or3_b32 v27, v108, v109, v110
    v_or_b32 v27, v27, v111
    v_and_b32 v27, 0xff, v27
    v_cmp_ne_u32 vcc, 0, v27
    s_cbranch_vccz L_h_retry_15_x
    s_sub_u32 s87, s87, 1
    s_cbranch_scc0 L_h_retry_15_l
L_h_retry_15_x:
    s_mov_b64 exec, -1
    s_nop 4
    s_branch L_h_ok_16
L_og_retry_17:
    s_mov_b32 s87, 4000000
L_og_retry_17_l:
    s_mov_b64 exec, vcc
    buffer_load_dwordx4 v[240:243], v92, s[56:59], s12 offen sc1
    buffer_load_dwordx4 v[244:247], v92, s[56:59], s13 offen sc1
    s_waitcnt vmcnt(0)
    v_xor_b32 v240, v5, v240
    v_xor_b32 v241, v5, v241
    v_xor_b32 v242, v5, v242
    v_xor_b32 v243, v5, v243
    v_xor_b32 v244, v5, v244
    v_xor_b32 v245, v5, v245
    v_xor_b32 v246, v5, v246
    v_xor_b32 v247, v5, v247
    v_or3_b32 v27, v240, v241, v242
    v_or3_b32 v27, v27, v243, v244
    v_or3_b32 v27, v27, v245, v246
    v_or_b32 v27, v27, v247
    v_and_b32 v27, 0xff, v27
    v_cmp_ne_u32 vcc, 0, v27
    s_cbranch_vccz L_og_retry_17_x
    s_sub_u32 s87, s87, 1
    s_cbranch_scc0 L_og_retry_17_l
L_og_retry_17_x:
    s_mov_b64 exec, -1
    s_nop 4
    s_branch L_og_ok_18
L_fin_retry_19:
    s_mov_b32 s87, 4000000
L_fin_retry_19_l:
    s_mov_b64 exec, vcc
    buffer_load_dwordx4 v[192:195], v95, s[56:59], s15 offen sc1
    buffer_load_dwordx4 v[196:199], v94, s[56:59], s16 offen sc1
    buffer_load_dwordx4 v[200:203], v94, s[56:59], s17 offen sc1
    s_waitcnt vmcnt(0)
    v_xor_b32 v192, v5, v192
    v_xor_b32 v193, v5, v193
    v_xor_b32 v194, v5, v194
    v_xor_b32 v195, v5, v195
    v_xor_b32 v196, v5, v196
    v_xor_b32 v197, v5, v197
    v_xor_b32 v198, v5, v198
    v_xor_b32 v199, v5, v199
    v_xor_b32 v200, v5, v200
    v_xor_b32 v201, v5, v201
    v_xor_b32 v202, v5, v202
    v_xor_b32 v203, v5, v203
    v_or3_b32 v27, v192, v193, v194
    v_or3_b32 v27, v27, v195, v196
    v_or3_b32 v27, v27, v197, v198
    v_or3_b32 v27, v27, v199, v200
    v_or3_b32 v27, v27, v201, v202
    v_or_b32 v27, v27, v203
    v_and_b32 v27, 0xff, v27
    v_cmp_ne_u32 vcc, 0, v27
    s_cbranch_vccz L_fin_retry_19_x
    s_sub_u32 s87, s87, 1
    s_cbranch_scc0 L_fin_retry_19_l
L_fin_retry_19_x:
    s_mov_b64 exec, -1
    s_nop 4
    s_branch L_fin_ok_20
L_og_retry_21:
    s_mov_b32 s87, 4000000
L_og_retry_21_l:
    s_mov_b64 exec, vcc
    buffer_load_dwordx4 v[240:243], v92, s[56:59], s12 offen sc1
    buffer_load_dwordx4 v[244:247], v92, s[56:59], s13 offen sc1
    s_waitcnt vmcnt(0)
    v_xor_b32 v240, v5, v240
    v_xor_b32 v241, v5, v241
    v_xor_b32 v242, v5, v242
    v_xor_b32 v243, v5, v243
    v_xor_b32 v244, v5, v244
    v_xor_b32 v245, v5, v245
    v_xor_b32 v246, v5, v246
    v_xor_b32 v247, v5, v247
    v_or3_b32 v27, v240, v241, v242
    v_or3_b32 v27, v27, v243, v244
    v_or3_b32 v27, v27, v245, v246
    v_or_b32 v27, v27, v247
    v_and_b32 v27, 0xff, v27
    v_cmp_ne_u32 vcc, 0, v27
    s_cbranch_vccz L_og_retry_21_x
    s_sub_u32 s87, s87, 1
    s_cbranch_scc0 L_og_retry_21_l
L_og_retry_21_x:
    s_mov_b64 exec, -1
    s_nop 4
    s_branch L_og_ok_22
L_og_retry_23:
    s_mov_b32 s87, 4000000
L_og_retry_23_l:
    s_mov_b64 exec, vcc
    buffer_load_dwordx4 v[240:243], v92, s[56:59], s12 offen sc1
    buffer_load_dwordx4 v[244:247], v92, s[56:59], s13 offen sc1
    s_waitcnt vmcnt(0)
    v_xor_b32 v240, v5, v240
    v_xor_b32 v241, v5, v241
    v_xor_b32 v242, v5, v242
    v_xor_b32 v243, v5, v243
    v_xor_b32 v244, v5, v244
    v_xor_b32 v245, v5, v245
    v_xor_b32 v246, v5, v246
    v_xor_b32 v247, v5, v247
    v_or3_b32 v27, v240, v241, v242
    v_or3_b32 v27, v27, v243, v244
    v_or3_b32 v27, v27, v245, v246
    v_or_b32 v27, v27, v247
    v_and_b32 v27, 0xff, v27
    v_cmp_ne_u32 vcc, 0, v27
    s_cbranch_vccz L_og_retry_23_x
    s_sub_u32 s87, s87, 1
    s_cbranch_scc0 L_og_retry_23_l
L_og_retry_23_x:
    s_mov_b64 exec, -1
    s_nop 4
    s_branch L_og_ok_24
L_codeend:
.section .rodata,"a"
.p2align 6
.amdhsa_kernel recurrent_scan__gqa_block_cached__swiglu_ffn__decode_kernel
  .amdhsa_next_free_vgpr 512
  .amdhsa_next_free_sgpr 102
  .amdhsa_accum_offset 256
  .amdhsa_group_segment_fixed_size 0
  .amdhsa_kernarg_size 96
  .amdhsa_user_sgpr_count 2
  .amdhsa_user_sgpr_kernarg_segment_ptr 1
  .amdhsa_system_sgpr_workgroup_id_x 1
  .amdhsa_float_denorm_mode_32 3
.end_amdhsa_kernel
```
